```python
import torch

def _softmax(x, axis=-1):
    return torch.softmax(x, dim=axis)

def _gelu(x):
    return torch.nn.functional.gelu(x, approximate='tanh')

def _silu(x):
    return torch.nn.functional.silu(x)

def _sigmoid(x):
    return torch.sigmoid(x)

def _layernorm(x, axis=-1, eps=1e-05):
    m = x.mean(dim=axis, keepdim=True)
    v = x.var(dim=axis, keepdim=True, unbiased=False)
    return (x - m) / torch.sqrt(v + eps)

def _scatter_add(tgt, idx, src, axis=0):
    return tgt.clone().index_add_(axis, idx, src)

def _segment_sum(src, seg, n):
    out = torch.zeros((n,) + src.shape[1:], dtype=src.dtype)
    return out.index_add_(0, seg, src)

def _pad(x, pw):
    flat = tuple((v for pair in reversed(pw) for v in pair))
    return torch.nn.functional.pad(x, flat)
kernel_name = 'standalone__video_timesformer__vision'

def setup_inputs():

    _w = lambda a: (lambda t: t.to(torch.bfloat16) if t.is_floating_point() else t)(torch.as_tensor(a))
    T = 7
    p = 14
    HW = 384 // p * p
    N = (HW // p) ** 2
    C = 384
    return {'x': _w((lambda *s: torch.randn(*s, dtype=torch.bfloat16) * 0.1)(1, T, N, C)), 'wqkv_t': _w((lambda *s: torch.randn(*s, dtype=torch.bfloat16) * 0.1)(C, 3 * C)), 'wo_t': _w((lambda *s: torch.randn(*s, dtype=torch.bfloat16) * 0.1)(C, C)), 'wqkv_s': _w((lambda *s: torch.randn(*s, dtype=torch.bfloat16) * 0.1)(C, 3 * C)), 'wo_s': _w((lambda *s: torch.randn(*s, dtype=torch.bfloat16) * 0.1)(C, C))}

def reference(x, wqkv_t, wo_t, wqkv_s, wo_s):
    B, T, N, C = x.shape
    scale = C ** (-0.5)
    xt = (lambda x, *d: x.permute(*d))(x, 0, 2, 1, 3).reshape(B * N, T, C)
    h = _layernorm(xt, axis=-1)
    qkv = h @ wqkv_t
    q, k, v = (qkv[..., :C].clone(), qkv[..., C:2 * C].clone(), qkv[..., 2 * C:].clone())
    a = _softmax(torch.einsum('btc,bsc->bts', q, k) * scale, axis=-1)
    xt = xt + torch.einsum('bts,bsc->btc', a, v) @ wo_t
    x1 = (lambda x, *d: x.permute(*d))(xt.reshape(B, N, T, C), 0, 2, 1, 3)
    xs = x1.reshape(B * T, N, C)
    h = _layernorm(xs, axis=-1)
    qkv = h @ wqkv_s
    q, k, v = (qkv[..., :C].clone(), qkv[..., C:2 * C].clone(), qkv[..., 2 * C:].clone())
    a = _softmax(torch.einsum('bnc,bmc->bnm', q, k) * scale, axis=-1)
    xs = xs + torch.einsum('bnm,bmc->bnc', a, v) @ wo_s
    return xs.reshape(B, T, N, C)
```

```asm
; @launch kernel=temporal_kernel grid=(255,1,1) block=(256,1,1) lds=142848
; @launch kernel=spatial_kernel grid=(184,1,1) block=(256,1,1) lds=163840
.amdgcn_target "amdgcn-amd-amdhsa--gfx950"
.text
.globl temporal_kernel
.p2align 8
.type temporal_kernel,@function
temporal_kernel:
    s_cmp_ge_u32 s2, 255
    s_cbranch_scc1 K1_END
    s_cmp_lt_u32 s2, 72
    s_cbranch_scc1 K0_FOLD
    s_sub_u32 s2, s2, 72
    s_load_dwordx2 s[4:5], s[0:1], 0
    s_load_dwordx4 s[48:51], s[0:1], 48
    v_lshrrev_b32 v1, 6, v0
    s_nop 0
    v_readfirstlane_b32 s16, v1
    v_and_b32 v10, 63, v0
    v_lshlrev_b32 v1, 4, v10
    v_and_b32 v11, 31, v10
    v_lshrrev_b32 v12, 5, v10
    v_lshrrev_b32 v13, 3, v11
    v_and_b32 v14, 7, v11
    s_lshl_b32 s18, s2, 2
    v_add_u32 v15, s18, v13
    v_cmp_gt_u32 s[30:31], 7, v14
    s_movk_i32 s19, 729
    v_cmp_gt_u32 s[32:33], s19, v15
    s_nop 0
    s_and_b64 s[30:31], s[30:31], s[32:33]
    v_mul_lo_u32 v2, v14, s19
    v_add_u32 v2, v2, v15
    s_movk_i32 s19, 768
    v_mul_lo_u32 v2, v2, s19
    v_lshl_add_u32 v2, v12, 3, v2
    s_mul_i32 s19, s16, 192
    v_add_u32 v2, s19, v2
    v_mov_b32 v248, 2130706432
    v_cndmask_b32 v2, v248, v2, s[30:31]
    s_mul_i32 s17, s16, 73728
    s_waitcnt lgkmcnt(0)
    s_mov_b32 s8, s4
    s_and_b32 s9, s5, 0xffff
    s_mov_b32 s10, 3919104
    s_mov_b32 s11, 0x00020000
    s_mov_b32 s12, s50
    s_and_b32 s13, s51, 0xffff
    s_mov_b32 s14, 268435456
    s_mov_b32 s15, 0x00020000
    s_mov_b32 s56, s48
    s_and_b32 s57, s49, 0xffff
    s_mov_b32 s58, 256
    s_mov_b32 s59, 0x00020000
    buffer_load_dwordx2 v[112:113], v2, s[8:11], 0 offen offset:0
    buffer_load_dwordx2 v[114:115], v2, s[8:11], 0 offen offset:16
    buffer_load_dwordx2 v[116:117], v2, s[8:11], 0 offen offset:32
    buffer_load_dwordx2 v[118:119], v2, s[8:11], 0 offen offset:48
    buffer_load_dwordx2 v[120:121], v2, s[8:11], 0 offen offset:64
    buffer_load_dwordx2 v[122:123], v2, s[8:11], 0 offen offset:80
    buffer_load_dwordx2 v[124:125], v2, s[8:11], 0 offen offset:96
    buffer_load_dwordx2 v[126:127], v2, s[8:11], 0 offen offset:112
    buffer_load_dwordx2 v[128:129], v2, s[8:11], 0 offen offset:128
    buffer_load_dwordx2 v[130:131], v2, s[8:11], 0 offen offset:144
    buffer_load_dwordx2 v[132:133], v2, s[8:11], 0 offen offset:160
    buffer_load_dwordx2 v[134:135], v2, s[8:11], 0 offen offset:176
    v_cmp_eq_u32 s[20:21], 0, v13
    v_cmp_eq_u32 s[22:23], 1, v13
    v_cmp_eq_u32 s[24:25], 2, v13
    v_cmp_eq_u32 s[26:27], 3, v13
    v_mul_u32_u24 v3, 784, v11
    v_add_u32 v3, 0x10800, v3
    s_mul_i32 s19, s16, 192
    v_add_u32 v3, s19, v3
    v_lshl_add_u32 v4, v12, 3, v3
    v_lshl_add_u32 v3, v12, 4, v3
    v_lshrrev_b32 v249, 3, v10
    v_and_b32 v250, 7, v10
    s_lshl_b32 s19, s16, 3
    v_add_u32 v251, s19, v249
    v_mul_u32_u24 v5, 784, v251
    v_lshl_add_u32 v5, v250, 4, v5
    v_add_u32 v5, 0x10800, v5
    s_lshl_b32 s42, s2, 2
    s_add_u32 s42, s42, s16
    s_and_b32 s43, s42, 3
    s_lshl_b32 s43, s43, 2
    s_bfe_u32 s44, s42, 0x20002
    s_or_b32 s43, s43, s44
    v_mul_u32_u24 v253, 2208, v249
    v_lshlrev_b32 v253, 8, v253
    s_mul_i32 s44, s42, 768
    v_add_u32 v253, s44, v253
    v_cmp_gt_u32 s[32:33], 7, v249
    s_cmp_lt_u32 s42, 729
    s_cselect_b64 s[32:33], s[32:33], 0
    v_cndmask_b32 v253, v248, v253, s[32:33]
    v_lshl_add_u32 v13, v250, 4, v253
    s_lshr_b32 s45, s42, 5
    s_mul_i32 s45, s45, 24576
    s_and_b32 s46, s42, 31
    s_lshl_b32 s46, s46, 8
    s_add_u32 s45, s45, s46
    s_sub_u32 s45, s45, s44
    v_add_u32 v253, s45, v253
    v_xor_b32 v251, s43, v250
    v_lshl_add_u32 v14, v251, 4, v253
    v_xor_b32 v251, 8, v251
    v_lshl_add_u32 v15, v251, 4, v253
    v_lshlrev_b32 v7, 3, v11
    v_add_u32 v7, 0x10000, v7
    s_lshl_b32 s19, s16, 8
    v_add_u32 v6, s19, v7
    v_and_b32 v249, 15, v10
    v_lshrrev_b32 v250, 2, v249
    v_lshl_add_u32 v250, v12, 2, v250
    v_lshlrev_b32 v8, 4, v250
    v_bfe_u32 v250, v10, 4, 1
    v_lshl_add_u32 v8, v250, 10, v8
    v_and_b32 v250, 1, v249
    v_lshl_add_u32 v8, v250, 9, v8
    v_bfe_u32 v250, v249, 1, 1
    v_lshl_add_u32 v8, v250, 3, v8
    s_mul_i32 s19, s16, 6144
    v_add_u32 v8, s19, v8
    v_add_u32 v9, s19, v1
    s_mov_b32 s28, 0
    s_mov_b32 s29, -1
    s_mov_b32 s34, 0xffff0000
    s_mov_b32 s35, 0x3f803f80
    s_mov_b32 s36, 0x3b2aaaab
    s_mov_b32 s37, 0x3727c5ac
    s_mov_b32 s40, 0xff800000
    s_waitcnt vmcnt(0)
    v_mov_b32 v248, 0
    v_mov_b32 v249, 0
    v_mov_b32 v250, 0
    v_mov_b32 v251, 0
    v_dot2c_f32_bf16 v248, s35, v112
    v_dot2c_f32_bf16 v250, v112, v112
    v_dot2c_f32_bf16 v249, s35, v113
    v_dot2c_f32_bf16 v251, v113, v113
    v_dot2c_f32_bf16 v248, s35, v114
    v_dot2c_f32_bf16 v250, v114, v114
    v_dot2c_f32_bf16 v249, s35, v115
    v_dot2c_f32_bf16 v251, v115, v115
    v_dot2c_f32_bf16 v248, s35, v116
    v_dot2c_f32_bf16 v250, v116, v116
    v_dot2c_f32_bf16 v249, s35, v117
    v_dot2c_f32_bf16 v251, v117, v117
    v_dot2c_f32_bf16 v248, s35, v118
    v_dot2c_f32_bf16 v250, v118, v118
    v_dot2c_f32_bf16 v249, s35, v119
    v_dot2c_f32_bf16 v251, v119, v119
    v_dot2c_f32_bf16 v248, s35, v120
    v_dot2c_f32_bf16 v250, v120, v120
    v_dot2c_f32_bf16 v249, s35, v121
    v_dot2c_f32_bf16 v251, v121, v121
    v_dot2c_f32_bf16 v248, s35, v122
    v_dot2c_f32_bf16 v250, v122, v122
    v_dot2c_f32_bf16 v249, s35, v123
    v_dot2c_f32_bf16 v251, v123, v123
    v_dot2c_f32_bf16 v248, s35, v124
    v_dot2c_f32_bf16 v250, v124, v124
    v_dot2c_f32_bf16 v249, s35, v125
    v_dot2c_f32_bf16 v251, v125, v125
    v_dot2c_f32_bf16 v248, s35, v126
    v_dot2c_f32_bf16 v250, v126, v126
    v_dot2c_f32_bf16 v249, s35, v127
    v_dot2c_f32_bf16 v251, v127, v127
    v_dot2c_f32_bf16 v248, s35, v128
    v_dot2c_f32_bf16 v250, v128, v128
    v_dot2c_f32_bf16 v249, s35, v129
    v_dot2c_f32_bf16 v251, v129, v129
    v_dot2c_f32_bf16 v248, s35, v130
    v_dot2c_f32_bf16 v250, v130, v130
    v_dot2c_f32_bf16 v249, s35, v131
    v_dot2c_f32_bf16 v251, v131, v131
    v_dot2c_f32_bf16 v248, s35, v132
    v_dot2c_f32_bf16 v250, v132, v132
    v_dot2c_f32_bf16 v249, s35, v133
    v_dot2c_f32_bf16 v251, v133, v133
    v_dot2c_f32_bf16 v248, s35, v134
    v_dot2c_f32_bf16 v250, v134, v134
    v_dot2c_f32_bf16 v249, s35, v135
    v_dot2c_f32_bf16 v251, v135, v135
    s_nop 1
    v_add_f32 v248, v248, v249
    v_add_f32 v249, v250, v251
    v_mov_b32 v250, v248
    v_mov_b32 v251, v249
    s_nop 0
    v_permlane32_swap_b32 v248, v250
    v_permlane32_swap_b32 v249, v251
    v_add_f32 v248, v248, v250
    v_add_f32 v249, v249, v251
    ds_write_b64 v6, v[248:249] offset:0
    s_waitcnt lgkmcnt(0)
    s_barrier
    ds_read_b64 v[232:233], v7 offset:0
    ds_read_b64 v[234:235], v7 offset:256
    ds_read_b64 v[236:237], v7 offset:512
    ds_read_b64 v[238:239], v7 offset:768
    v_lshlrev_b32 v16, 16, v112
    v_and_b32 v17, s34, v112
    v_lshlrev_b32 v18, 16, v113
    v_and_b32 v19, s34, v113
    v_lshlrev_b32 v20, 16, v114
    v_and_b32 v21, s34, v114
    v_lshlrev_b32 v22, 16, v115
    v_and_b32 v23, s34, v115
    v_lshlrev_b32 v24, 16, v116
    v_and_b32 v25, s34, v116
    v_lshlrev_b32 v26, 16, v117
    v_and_b32 v27, s34, v117
    v_lshlrev_b32 v28, 16, v118
    v_and_b32 v29, s34, v118
    v_lshlrev_b32 v30, 16, v119
    v_and_b32 v31, s34, v119
    v_lshlrev_b32 v32, 16, v120
    v_and_b32 v33, s34, v120
    v_lshlrev_b32 v34, 16, v121
    v_and_b32 v35, s34, v121
    v_lshlrev_b32 v36, 16, v122
    v_and_b32 v37, s34, v122
    v_lshlrev_b32 v38, 16, v123
    v_and_b32 v39, s34, v123
    v_lshlrev_b32 v40, 16, v124
    v_and_b32 v41, s34, v124
    v_lshlrev_b32 v42, 16, v125
    v_and_b32 v43, s34, v125
    v_lshlrev_b32 v44, 16, v126
    v_and_b32 v45, s34, v126
    v_lshlrev_b32 v46, 16, v127
    v_and_b32 v47, s34, v127
    v_lshlrev_b32 v48, 16, v128
    v_and_b32 v49, s34, v128
    v_lshlrev_b32 v50, 16, v129
    v_and_b32 v51, s34, v129
    v_lshlrev_b32 v52, 16, v130
    v_and_b32 v53, s34, v130
    v_lshlrev_b32 v54, 16, v131
    v_and_b32 v55, s34, v131
    v_lshlrev_b32 v56, 16, v132
    v_and_b32 v57, s34, v132
    v_lshlrev_b32 v58, 16, v133
    v_and_b32 v59, s34, v133
    v_lshlrev_b32 v60, 16, v134
    v_and_b32 v61, s34, v134
    v_lshlrev_b32 v62, 16, v135
    v_and_b32 v63, s34, v135
    s_waitcnt lgkmcnt(0)
    v_pk_add_f32 v[248:249], v[232:233], v[234:235]
    v_pk_add_f32 v[250:251], v[236:237], v[238:239]
    v_pk_add_f32 v[248:249], v[248:249], v[250:251]
    v_mul_f32 v248, s36, v248
    v_mul_f32 v249, s36, v249
    v_fma_f32 v249, -v248, v248, v249
    v_max_f32 v249, 0, v249
    v_add_f32 v249, s37, v249
    v_rsq_f32 v250, v249
    s_nop 0
    v_mul_f32 v252, v248, v250
    v_pk_fma_f32 v[248:249], v[16:17], v[250:251], v[252:253] op_sel_hi:[1,0,0] neg_lo:[0,0,1] neg_hi:[0,0,1]
    v_cvt_pk_bf16_f32 v112, v248, v249
    v_pk_fma_f32 v[254:255], v[18:19], v[250:251], v[252:253] op_sel_hi:[1,0,0] neg_lo:[0,0,1] neg_hi:[0,0,1]
    v_cvt_pk_bf16_f32 v113, v254, v255
    v_pk_fma_f32 v[248:249], v[20:21], v[250:251], v[252:253] op_sel_hi:[1,0,0] neg_lo:[0,0,1] neg_hi:[0,0,1]
    v_cvt_pk_bf16_f32 v114, v248, v249
    v_pk_fma_f32 v[254:255], v[22:23], v[250:251], v[252:253] op_sel_hi:[1,0,0] neg_lo:[0,0,1] neg_hi:[0,0,1]
    v_cvt_pk_bf16_f32 v115, v254, v255
    v_pk_fma_f32 v[248:249], v[24:25], v[250:251], v[252:253] op_sel_hi:[1,0,0] neg_lo:[0,0,1] neg_hi:[0,0,1]
    v_cvt_pk_bf16_f32 v116, v248, v249
    v_pk_fma_f32 v[254:255], v[26:27], v[250:251], v[252:253] op_sel_hi:[1,0,0] neg_lo:[0,0,1] neg_hi:[0,0,1]
    v_cvt_pk_bf16_f32 v117, v254, v255
    v_pk_fma_f32 v[248:249], v[28:29], v[250:251], v[252:253] op_sel_hi:[1,0,0] neg_lo:[0,0,1] neg_hi:[0,0,1]
    v_cvt_pk_bf16_f32 v118, v248, v249
    v_pk_fma_f32 v[254:255], v[30:31], v[250:251], v[252:253] op_sel_hi:[1,0,0] neg_lo:[0,0,1] neg_hi:[0,0,1]
    v_cvt_pk_bf16_f32 v119, v254, v255
    v_pk_fma_f32 v[248:249], v[32:33], v[250:251], v[252:253] op_sel_hi:[1,0,0] neg_lo:[0,0,1] neg_hi:[0,0,1]
    v_cvt_pk_bf16_f32 v120, v248, v249
    v_pk_fma_f32 v[254:255], v[34:35], v[250:251], v[252:253] op_sel_hi:[1,0,0] neg_lo:[0,0,1] neg_hi:[0,0,1]
    v_cvt_pk_bf16_f32 v121, v254, v255
    v_pk_fma_f32 v[248:249], v[36:37], v[250:251], v[252:253] op_sel_hi:[1,0,0] neg_lo:[0,0,1] neg_hi:[0,0,1]
    v_cvt_pk_bf16_f32 v122, v248, v249
    v_pk_fma_f32 v[254:255], v[38:39], v[250:251], v[252:253] op_sel_hi:[1,0,0] neg_lo:[0,0,1] neg_hi:[0,0,1]
    v_cvt_pk_bf16_f32 v123, v254, v255
    v_pk_fma_f32 v[248:249], v[40:41], v[250:251], v[252:253] op_sel_hi:[1,0,0] neg_lo:[0,0,1] neg_hi:[0,0,1]
    v_cvt_pk_bf16_f32 v124, v248, v249
    v_pk_fma_f32 v[254:255], v[42:43], v[250:251], v[252:253] op_sel_hi:[1,0,0] neg_lo:[0,0,1] neg_hi:[0,0,1]
    v_cvt_pk_bf16_f32 v125, v254, v255
    v_pk_fma_f32 v[248:249], v[44:45], v[250:251], v[252:253] op_sel_hi:[1,0,0] neg_lo:[0,0,1] neg_hi:[0,0,1]
    v_cvt_pk_bf16_f32 v126, v248, v249
    v_pk_fma_f32 v[254:255], v[46:47], v[250:251], v[252:253] op_sel_hi:[1,0,0] neg_lo:[0,0,1] neg_hi:[0,0,1]
    v_cvt_pk_bf16_f32 v127, v254, v255
    v_pk_fma_f32 v[248:249], v[48:49], v[250:251], v[252:253] op_sel_hi:[1,0,0] neg_lo:[0,0,1] neg_hi:[0,0,1]
    v_cvt_pk_bf16_f32 v128, v248, v249
    v_pk_fma_f32 v[254:255], v[50:51], v[250:251], v[252:253] op_sel_hi:[1,0,0] neg_lo:[0,0,1] neg_hi:[0,0,1]
    v_cvt_pk_bf16_f32 v129, v254, v255
    v_pk_fma_f32 v[248:249], v[52:53], v[250:251], v[252:253] op_sel_hi:[1,0,0] neg_lo:[0,0,1] neg_hi:[0,0,1]
    v_cvt_pk_bf16_f32 v130, v248, v249
    v_pk_fma_f32 v[254:255], v[54:55], v[250:251], v[252:253] op_sel_hi:[1,0,0] neg_lo:[0,0,1] neg_hi:[0,0,1]
    v_cvt_pk_bf16_f32 v131, v254, v255
    v_pk_fma_f32 v[248:249], v[56:57], v[250:251], v[252:253] op_sel_hi:[1,0,0] neg_lo:[0,0,1] neg_hi:[0,0,1]
    v_cvt_pk_bf16_f32 v132, v248, v249
    v_pk_fma_f32 v[254:255], v[58:59], v[250:251], v[252:253] op_sel_hi:[1,0,0] neg_lo:[0,0,1] neg_hi:[0,0,1]
    v_cvt_pk_bf16_f32 v133, v254, v255
    v_pk_fma_f32 v[248:249], v[60:61], v[250:251], v[252:253] op_sel_hi:[1,0,0] neg_lo:[0,0,1] neg_hi:[0,0,1]
    v_cvt_pk_bf16_f32 v134, v248, v249
    v_pk_fma_f32 v[254:255], v[62:63], v[250:251], v[252:253] op_sel_hi:[1,0,0] neg_lo:[0,0,1] neg_hi:[0,0,1]
    v_cvt_pk_bf16_f32 v135, v254, v255
    s_cmp_lg_u32 s16, 0
    s_cbranch_scc1 K1_PD_1
    v_mov_b32 v10, 112
    s_mov_b32 s46, 400000
K1_POLL_2:
    buffer_load_dwordx2 v[254:255], v10, s[56:59], 0 offen sc1
    s_waitcnt vmcnt(0)
    v_min_u32 v11, v254, v255
    s_nop 0
    v_readfirstlane_b32 s47, v11
    s_cmp_ge_u32 s47, 36
    s_cbranch_scc1 K1_PD_1
    s_sleep 8
    s_sub_u32 s46, s46, 1
    s_cmp_lg_u32 s46, 0
    s_cbranch_scc1 K1_POLL_2
K1_PD_1:
    s_waitcnt vmcnt(0)
    s_barrier
    s_add_u32 s18, s17, 0
    buffer_load_dwordx4 a[0:3], v1, s[12:15], s18 offen offset:0 sc1
    buffer_load_dwordx4 a[4:7], v1, s[12:15], s18 offen offset:1024 sc1
    buffer_load_dwordx4 a[8:11], v1, s[12:15], s18 offen offset:2048 sc1
    buffer_load_dwordx4 a[12:15], v1, s[12:15], s18 offen offset:3072 sc1
    s_add_u32 s18, s17, 4096
    buffer_load_dwordx4 a[16:19], v1, s[12:15], s18 offen offset:0 sc1
    buffer_load_dwordx4 a[20:23], v1, s[12:15], s18 offen offset:1024 sc1
    buffer_load_dwordx4 a[24:27], v1, s[12:15], s18 offen offset:2048 sc1
    buffer_load_dwordx4 a[28:31], v1, s[12:15], s18 offen offset:3072 sc1
    s_add_u32 s18, s17, 8192
    buffer_load_dwordx4 a[32:35], v1, s[12:15], s18 offen offset:0 sc1
    buffer_load_dwordx4 a[36:39], v1, s[12:15], s18 offen offset:1024 sc1
    buffer_load_dwordx4 a[40:43], v1, s[12:15], s18 offen offset:2048 sc1
    buffer_load_dwordx4 a[44:47], v1, s[12:15], s18 offen offset:3072 sc1
    ds_write_b128 v9, v[112:115] offset:0
    ds_write_b128 v9, v[116:119] offset:1024
    ds_write_b128 v9, v[120:123] offset:2048
    ds_write_b128 v9, v[124:127] offset:3072
    ds_write_b128 v9, v[128:131] offset:4096
    ds_write_b128 v9, v[132:135] offset:5120
    s_add_u32 s18, s17, 12288
    buffer_load_dwordx4 a[48:51], v1, s[12:15], s18 offen offset:0 sc1
    buffer_load_dwordx4 a[52:55], v1, s[12:15], s18 offen offset:1024 sc1
    buffer_load_dwordx4 a[56:59], v1, s[12:15], s18 offen offset:2048 sc1
    buffer_load_dwordx4 a[60:63], v1, s[12:15], s18 offen offset:3072 sc1
    s_add_u32 s18, s17, 16384
    buffer_load_dwordx4 a[64:67], v1, s[12:15], s18 offen offset:0 sc1
    buffer_load_dwordx4 a[68:71], v1, s[12:15], s18 offen offset:1024 sc1
    s_waitcnt lgkmcnt(0)
    s_barrier
    ds_read_b128 v[136:139], v1 offset:0
    ds_read_b128 v[140:143], v1 offset:1024
    ds_read_b128 v[144:147], v1 offset:2048
    ds_read_b128 v[148:151], v1 offset:3072
    ds_read_b128 v[152:155], v1 offset:4096
    ds_read_b128 v[156:159], v1 offset:5120
    ds_read_b128 v[160:163], v1 offset:6144
    ds_read_b128 v[164:167], v1 offset:7168
    ds_read_b128 v[168:171], v1 offset:8192
    ds_read_b128 v[172:175], v1 offset:9216
    ds_read_b128 v[176:179], v1 offset:10240
    ds_read_b128 v[180:183], v1 offset:11264
    ds_read_b128 v[184:187], v1 offset:12288
    buffer_load_dwordx4 a[72:75], v1, s[12:15], s18 offen offset:2048 sc1
    ds_read_b128 v[188:191], v1 offset:13312
    ds_read_b128 v[192:195], v1 offset:14336
    ds_read_b128 v[196:199], v1 offset:15360
    ds_read_b128 v[200:203], v1 offset:16384
    ds_read_b128 v[204:207], v1 offset:17408
    ds_read_b128 v[208:211], v1 offset:18432
    ds_read_b128 v[212:215], v1 offset:19456
    ds_read_b128 v[216:219], v1 offset:20480
    ds_read_b128 v[220:223], v1 offset:21504
    ds_read_b128 v[224:227], v1 offset:22528
    ds_read_b128 v[228:231], v1 offset:23552
    s_waitcnt vmcnt(18)
    s_waitcnt lgkmcnt(15)
    v_mfma_f32_32x32x16_bf16 v[64:79], a[0:3], v[136:139], 0
    buffer_load_dwordx4 a[76:79], v1, s[12:15], s18 offen offset:3072 sc1
    s_waitcnt vmcnt(18)
    v_mfma_f32_32x32x16_bf16 v[64:79], a[4:7], v[140:143], v[64:79]
    s_waitcnt vmcnt(17)
    v_mfma_f32_32x32x16_bf16 v[64:79], a[8:11], v[144:147], v[64:79]
    s_add_u32 s18, s17, 20480
    buffer_load_dwordx4 a[80:83], v1, s[12:15], s18 offen offset:0 sc1
    s_waitcnt vmcnt(17)
    v_mfma_f32_32x32x16_bf16 v[64:79], a[12:15], v[148:151], v[64:79]
    s_waitcnt vmcnt(16)
    v_mfma_f32_32x32x16_bf16 v[64:79], a[16:19], v[152:155], v[64:79]
    buffer_load_dwordx4 a[84:87], v1, s[12:15], s18 offen offset:1024 sc1
    s_waitcnt vmcnt(16)
    v_mfma_f32_32x32x16_bf16 v[64:79], a[20:23], v[156:159], v[64:79]
    s_waitcnt vmcnt(15)
    v_mfma_f32_32x32x16_bf16 v[64:79], a[24:27], v[160:163], v[64:79]
    buffer_load_dwordx4 a[88:91], v1, s[12:15], s18 offen offset:2048 sc1
    s_waitcnt vmcnt(15)
    v_mfma_f32_32x32x16_bf16 v[64:79], a[28:31], v[164:167], v[64:79]
    buffer_load_dwordx4 a[92:95], v1, s[12:15], s18 offen offset:3072 sc1
    s_waitcnt vmcnt(15)
    v_mfma_f32_32x32x16_bf16 v[64:79], a[32:35], v[168:171], v[64:79]
    s_add_u32 s18, s17, 24576
    buffer_load_dwordx4 a[96:99], v1, s[12:15], s18 offen offset:0 sc1
    s_waitcnt vmcnt(15)
    s_waitcnt lgkmcnt(14)
    v_mfma_f32_32x32x16_bf16 v[64:79], a[36:39], v[172:175], v[64:79]
    buffer_load_dwordx4 a[100:103], v1, s[12:15], s18 offen offset:1024 sc1
    s_waitcnt vmcnt(15)
    s_waitcnt lgkmcnt(13)
    v_mfma_f32_32x32x16_bf16 v[64:79], a[40:43], v[176:179], v[64:79]
    buffer_load_dwordx4 a[104:107], v1, s[12:15], s18 offen offset:2048 sc1
    s_waitcnt vmcnt(15)
    s_waitcnt lgkmcnt(12)
    v_mfma_f32_32x32x16_bf16 v[64:79], a[44:47], v[180:183], v[64:79]
    buffer_load_dwordx4 a[108:111], v1, s[12:15], s18 offen offset:3072 sc1
    s_waitcnt vmcnt(15)
    s_waitcnt lgkmcnt(11)
    v_mfma_f32_32x32x16_bf16 v[64:79], a[48:51], v[184:187], v[64:79]
    s_add_u32 s18, s17, 28672
    buffer_load_dwordx4 a[112:115], v1, s[12:15], s18 offen offset:0 sc1
    s_waitcnt vmcnt(15)
    s_waitcnt lgkmcnt(10)
    v_mfma_f32_32x32x16_bf16 v[64:79], a[52:55], v[188:191], v[64:79]
    buffer_load_dwordx4 a[116:119], v1, s[12:15], s18 offen offset:1024 sc1
    s_waitcnt vmcnt(15)
    s_waitcnt lgkmcnt(9)
    v_mfma_f32_32x32x16_bf16 v[64:79], a[56:59], v[192:195], v[64:79]
    buffer_load_dwordx4 a[120:123], v1, s[12:15], s18 offen offset:2048 sc1
    s_waitcnt vmcnt(15)
    s_waitcnt lgkmcnt(8)
    v_mfma_f32_32x32x16_bf16 v[64:79], a[60:63], v[196:199], v[64:79]
    buffer_load_dwordx4 a[124:127], v1, s[12:15], s18 offen offset:3072 sc1
    s_waitcnt vmcnt(15)
    s_waitcnt lgkmcnt(7)
    v_mfma_f32_32x32x16_bf16 v[64:79], a[64:67], v[200:203], v[64:79]
    s_add_u32 s18, s17, 32768
    buffer_load_dwordx4 a[128:131], v1, s[12:15], s18 offen offset:0 sc1
    s_waitcnt vmcnt(15)
    s_waitcnt lgkmcnt(6)
    v_mfma_f32_32x32x16_bf16 v[64:79], a[68:71], v[204:207], v[64:79]
    buffer_load_dwordx4 a[132:135], v1, s[12:15], s18 offen offset:1024 sc1
    s_waitcnt vmcnt(15)
    s_waitcnt lgkmcnt(5)
    v_mfma_f32_32x32x16_bf16 v[64:79], a[72:75], v[208:211], v[64:79]
    buffer_load_dwordx4 a[136:139], v1, s[12:15], s18 offen offset:2048 sc1
    s_waitcnt vmcnt(15)
    s_waitcnt lgkmcnt(4)
    v_mfma_f32_32x32x16_bf16 v[64:79], a[76:79], v[212:215], v[64:79]
    buffer_load_dwordx4 a[140:143], v1, s[12:15], s18 offen offset:3072 sc1
    s_waitcnt vmcnt(15)
    s_waitcnt lgkmcnt(3)
    v_mfma_f32_32x32x16_bf16 v[64:79], a[80:83], v[216:219], v[64:79]
    s_add_u32 s18, s17, 36864
    buffer_load_dwordx4 a[144:147], v1, s[12:15], s18 offen offset:0 sc1
    s_waitcnt vmcnt(15)
    s_waitcnt lgkmcnt(2)
    v_mfma_f32_32x32x16_bf16 v[64:79], a[84:87], v[220:223], v[64:79]
    buffer_load_dwordx4 a[148:151], v1, s[12:15], s18 offen offset:1024 sc1
    s_waitcnt vmcnt(15)
    s_waitcnt lgkmcnt(1)
    v_mfma_f32_32x32x16_bf16 v[64:79], a[88:91], v[224:227], v[64:79]
    buffer_load_dwordx4 a[152:155], v1, s[12:15], s18 offen offset:2048 sc1
    s_waitcnt vmcnt(15)
    s_waitcnt lgkmcnt(0)
    v_mfma_f32_32x32x16_bf16 v[64:79], a[92:95], v[228:231], v[64:79]
    buffer_load_dwordx4 a[156:159], v1, s[12:15], s18 offen offset:3072 sc1
    s_waitcnt vmcnt(15)
    v_mfma_f32_32x32x16_bf16 v[80:95], a[96:99], v[136:139], 0
    s_add_u32 s18, s17, 40960
    buffer_load_dwordx4 a[160:163], v1, s[12:15], s18 offen offset:0 sc1
    s_waitcnt vmcnt(15)
    v_mfma_f32_32x32x16_bf16 v[80:95], a[100:103], v[140:143], v[80:95]
    buffer_load_dwordx4 a[164:167], v1, s[12:15], s18 offen offset:1024 sc1
    s_waitcnt vmcnt(15)
    v_mfma_f32_32x32x16_bf16 v[80:95], a[104:107], v[144:147], v[80:95]
    buffer_load_dwordx4 a[168:171], v1, s[12:15], s18 offen offset:2048 sc1
    s_waitcnt vmcnt(15)
    v_mfma_f32_32x32x16_bf16 v[80:95], a[108:111], v[148:151], v[80:95]
    buffer_load_dwordx4 a[172:175], v1, s[12:15], s18 offen offset:3072 sc1
    s_waitcnt vmcnt(15)
    v_mfma_f32_32x32x16_bf16 v[80:95], a[112:115], v[152:155], v[80:95]
    s_add_u32 s18, s17, 45056
    buffer_load_dwordx4 a[176:179], v1, s[12:15], s18 offen offset:0 sc1
    s_waitcnt vmcnt(15)
    v_mfma_f32_32x32x16_bf16 v[80:95], a[116:119], v[156:159], v[80:95]
    buffer_load_dwordx4 a[180:183], v1, s[12:15], s18 offen offset:1024 sc1
    s_waitcnt vmcnt(15)
    v_mfma_f32_32x32x16_bf16 v[80:95], a[120:123], v[160:163], v[80:95]
    buffer_load_dwordx4 a[184:187], v1, s[12:15], s18 offen offset:2048 sc1
    s_waitcnt vmcnt(15)
    v_mfma_f32_32x32x16_bf16 v[80:95], a[124:127], v[164:167], v[80:95]
    buffer_load_dwordx4 a[188:191], v1, s[12:15], s18 offen offset:3072 sc1
    s_waitcnt vmcnt(15)
    v_mfma_f32_32x32x16_bf16 v[80:95], a[128:131], v[168:171], v[80:95]
    s_add_u32 s18, s17, 49152
    buffer_load_dwordx4 a[192:195], v1, s[12:15], s18 offen offset:0 sc1
    s_waitcnt vmcnt(15)
    v_mfma_f32_32x32x16_bf16 v[80:95], a[132:135], v[172:175], v[80:95]
    buffer_load_dwordx4 a[196:199], v1, s[12:15], s18 offen offset:1024 sc1
    s_waitcnt vmcnt(15)
    v_mfma_f32_32x32x16_bf16 v[80:95], a[136:139], v[176:179], v[80:95]
    buffer_load_dwordx4 a[200:203], v1, s[12:15], s18 offen offset:2048 sc1
    s_waitcnt vmcnt(15)
    v_mfma_f32_32x32x16_bf16 v[80:95], a[140:143], v[180:183], v[80:95]
    buffer_load_dwordx4 a[204:207], v1, s[12:15], s18 offen offset:3072 sc1
    s_waitcnt vmcnt(15)
    v_mfma_f32_32x32x16_bf16 v[80:95], a[144:147], v[184:187], v[80:95]
    s_add_u32 s18, s17, 53248
    buffer_load_dwordx4 a[208:211], v1, s[12:15], s18 offen offset:0 sc1
    s_waitcnt vmcnt(15)
    v_mfma_f32_32x32x16_bf16 v[80:95], a[148:151], v[188:191], v[80:95]
    buffer_load_dwordx4 a[212:215], v1, s[12:15], s18 offen offset:1024 sc1
    s_waitcnt vmcnt(15)
    v_mfma_f32_32x32x16_bf16 v[80:95], a[152:155], v[192:195], v[80:95]
    buffer_load_dwordx4 a[216:219], v1, s[12:15], s18 offen offset:2048 sc1
    s_waitcnt vmcnt(15)
    v_mfma_f32_32x32x16_bf16 v[80:95], a[156:159], v[196:199], v[80:95]
    buffer_load_dwordx4 a[220:223], v1, s[12:15], s18 offen offset:3072 sc1
    s_waitcnt vmcnt(15)
    v_mfma_f32_32x32x16_bf16 v[80:95], a[160:163], v[200:203], v[80:95]
    s_add_u32 s18, s17, 57344
    buffer_load_dwordx4 a[224:227], v1, s[12:15], s18 offen offset:0 sc1
    s_waitcnt vmcnt(15)
    v_mfma_f32_32x32x16_bf16 v[80:95], a[164:167], v[204:207], v[80:95]
    buffer_load_dwordx4 a[228:231], v1, s[12:15], s18 offen offset:1024 sc1
    s_waitcnt vmcnt(15)
    v_mfma_f32_32x32x16_bf16 v[80:95], a[168:171], v[208:211], v[80:95]
    buffer_load_dwordx4 a[232:235], v1, s[12:15], s18 offen offset:2048 sc1
    s_waitcnt vmcnt(15)
    v_mfma_f32_32x32x16_bf16 v[80:95], a[172:175], v[212:215], v[80:95]
    buffer_load_dwordx4 a[236:239], v1, s[12:15], s18 offen offset:3072 sc1
    s_waitcnt vmcnt(15)
    v_mfma_f32_32x32x16_bf16 v[80:95], a[176:179], v[216:219], v[80:95]
    s_add_u32 s18, s17, 61440
    buffer_load_dwordx4 a[0:3], v1, s[12:15], s18 offen offset:0 sc1
    s_waitcnt vmcnt(15)
    v_mfma_f32_32x32x16_bf16 v[80:95], a[180:183], v[220:223], v[80:95]
    buffer_load_dwordx4 a[4:7], v1, s[12:15], s18 offen offset:1024 sc1
    s_waitcnt vmcnt(15)
    v_mfma_f32_32x32x16_bf16 v[80:95], a[184:187], v[224:227], v[80:95]
    buffer_load_dwordx4 a[8:11], v1, s[12:15], s18 offen offset:2048 sc1
    s_waitcnt vmcnt(15)
    v_mfma_f32_32x32x16_bf16 v[80:95], a[188:191], v[228:231], v[80:95]
    buffer_load_dwordx4 a[12:15], v1, s[12:15], s18 offen offset:3072 sc1
    s_waitcnt vmcnt(15)
    v_mfma_f32_32x32x16_bf16 v[96:111], a[192:195], v[136:139], 0
    s_add_u32 s18, s17, 65536
    buffer_load_dwordx4 a[16:19], v1, s[12:15], s18 offen offset:0 sc1
    s_waitcnt vmcnt(15)
    v_mfma_f32_32x32x16_bf16 v[96:111], a[196:199], v[140:143], v[96:111]
    buffer_load_dwordx4 a[20:23], v1, s[12:15], s18 offen offset:1024 sc1
    s_waitcnt vmcnt(15)
    v_mfma_f32_32x32x16_bf16 v[96:111], a[200:203], v[144:147], v[96:111]
    buffer_load_dwordx4 a[24:27], v1, s[12:15], s18 offen offset:2048 sc1
    s_waitcnt vmcnt(15)
    v_mfma_f32_32x32x16_bf16 v[96:111], a[204:207], v[148:151], v[96:111]
    buffer_load_dwordx4 a[28:31], v1, s[12:15], s18 offen offset:3072 sc1
    s_waitcnt vmcnt(15)
    v_mfma_f32_32x32x16_bf16 v[96:111], a[208:211], v[152:155], v[96:111]
    s_add_u32 s18, s17, 69632
    buffer_load_dwordx4 a[32:35], v1, s[12:15], s18 offen offset:0 sc1
    s_waitcnt vmcnt(15)
    v_mfma_f32_32x32x16_bf16 v[96:111], a[212:215], v[156:159], v[96:111]
    buffer_load_dwordx4 a[36:39], v1, s[12:15], s18 offen offset:1024 sc1
    s_waitcnt vmcnt(15)
    v_mfma_f32_32x32x16_bf16 v[96:111], a[216:219], v[160:163], v[96:111]
    buffer_load_dwordx4 a[40:43], v1, s[12:15], s18 offen offset:2048 sc1
    s_waitcnt vmcnt(15)
    v_mfma_f32_32x32x16_bf16 v[96:111], a[220:223], v[164:167], v[96:111]
    buffer_load_dwordx4 a[44:47], v1, s[12:15], s18 offen offset:3072 sc1
    s_waitcnt vmcnt(15)
    v_mfma_f32_32x32x16_bf16 v[96:111], a[224:227], v[168:171], v[96:111]
    s_add_u32 s18, s17, 294912
    buffer_load_dwordx4 a[48:51], v1, s[12:15], s18 offen offset:0 sc1
    s_waitcnt vmcnt(15)
    v_mfma_f32_32x32x16_bf16 v[96:111], a[228:231], v[172:175], v[96:111]
    buffer_load_dwordx4 a[52:55], v1, s[12:15], s18 offen offset:1024 sc1
    s_waitcnt vmcnt(15)
    v_mfma_f32_32x32x16_bf16 v[96:111], a[232:235], v[176:179], v[96:111]
    buffer_load_dwordx4 a[56:59], v1, s[12:15], s18 offen offset:2048 sc1
    s_waitcnt vmcnt(15)
    v_mfma_f32_32x32x16_bf16 v[96:111], a[236:239], v[180:183], v[96:111]
    buffer_load_dwordx4 a[60:63], v1, s[12:15], s18 offen offset:3072 sc1
    s_waitcnt vmcnt(15)
    v_mfma_f32_32x32x16_bf16 v[96:111], a[0:3], v[184:187], v[96:111]
    s_add_u32 s18, s17, 299008
    buffer_load_dwordx4 a[64:67], v1, s[12:15], s18 offen offset:0 sc1
    s_waitcnt vmcnt(15)
    v_mfma_f32_32x32x16_bf16 v[96:111], a[4:7], v[188:191], v[96:111]
    buffer_load_dwordx4 a[68:71], v1, s[12:15], s18 offen offset:1024 sc1
    s_waitcnt vmcnt(15)
    v_mfma_f32_32x32x16_bf16 v[96:111], a[8:11], v[192:195], v[96:111]
    buffer_load_dwordx4 a[72:75], v1, s[12:15], s18 offen offset:2048 sc1
    s_waitcnt vmcnt(15)
    v_mfma_f32_32x32x16_bf16 v[96:111], a[12:15], v[196:199], v[96:111]
    buffer_load_dwordx4 a[76:79], v1, s[12:15], s18 offen offset:3072 sc1
    s_waitcnt vmcnt(15)
    v_mfma_f32_32x32x16_bf16 v[96:111], a[16:19], v[200:203], v[96:111]
    s_add_u32 s18, s17, 303104
    buffer_load_dwordx4 a[80:83], v1, s[12:15], s18 offen offset:0 sc1
    s_waitcnt vmcnt(15)
    v_mfma_f32_32x32x16_bf16 v[96:111], a[20:23], v[204:207], v[96:111]
    buffer_load_dwordx4 a[84:87], v1, s[12:15], s18 offen offset:1024 sc1
    s_waitcnt vmcnt(15)
    v_mfma_f32_32x32x16_bf16 v[96:111], a[24:27], v[208:211], v[96:111]
    buffer_load_dwordx4 a[88:91], v1, s[12:15], s18 offen offset:2048 sc1
    s_waitcnt vmcnt(15)
    v_mfma_f32_32x32x16_bf16 v[96:111], a[28:31], v[212:215], v[96:111]
    buffer_load_dwordx4 a[92:95], v1, s[12:15], s18 offen offset:3072 sc1
    s_waitcnt vmcnt(15)
    v_mfma_f32_32x32x16_bf16 v[96:111], a[32:35], v[216:219], v[96:111]
    s_add_u32 s18, s17, 307200
    buffer_load_dwordx4 a[96:99], v1, s[12:15], s18 offen offset:0 sc1
    s_waitcnt vmcnt(15)
    v_mfma_f32_32x32x16_bf16 v[96:111], a[36:39], v[220:223], v[96:111]
    buffer_load_dwordx4 a[100:103], v1, s[12:15], s18 offen offset:1024 sc1
    s_waitcnt vmcnt(15)
    v_mfma_f32_32x32x16_bf16 v[96:111], a[40:43], v[224:227], v[96:111]
    buffer_load_dwordx4 a[104:107], v1, s[12:15], s18 offen offset:2048 sc1
    s_waitcnt vmcnt(15)
    v_mfma_f32_32x32x16_bf16 v[96:111], a[44:47], v[228:231], v[96:111]
    buffer_load_dwordx4 a[108:111], v1, s[12:15], s18 offen offset:3072 sc1
    ds_read_b128 v[136:139], v9 offset:0
    ds_read_b128 v[140:143], v9 offset:1024
    ds_read_b128 v[144:147], v9 offset:2048
    ds_read_b128 v[148:151], v9 offset:3072
    ds_read_b128 v[152:155], v9 offset:4096
    ds_read_b128 v[156:159], v9 offset:5120
    v_cvt_pk_bf16_f32 v112, v64, v65
    v_cvt_pk_bf16_f32 v113, v66, v67
    v_cvt_pk_bf16_f32 v114, v68, v69
    v_cvt_pk_bf16_f32 v115, v70, v71
    v_cvt_pk_bf16_f32 v116, v72, v73
    v_cvt_pk_bf16_f32 v117, v74, v75
    v_cvt_pk_bf16_f32 v118, v76, v77
    v_cvt_pk_bf16_f32 v119, v78, v79
    v_cvt_pk_bf16_f32 v120, v80, v81
    s_add_u32 s18, s17, 311296
    buffer_load_dwordx4 a[112:115], v1, s[12:15], s18 offen offset:0 sc1
    v_cvt_pk_bf16_f32 v121, v82, v83
    v_cvt_pk_bf16_f32 v122, v84, v85
    v_cvt_pk_bf16_f32 v123, v86, v87
    v_cvt_pk_bf16_f32 v124, v88, v89
    v_cvt_pk_bf16_f32 v125, v90, v91
    v_cvt_pk_bf16_f32 v126, v92, v93
    v_cvt_pk_bf16_f32 v127, v94, v95
    v_cvt_pk_bf16_f32 v128, v96, v97
    v_cvt_pk_bf16_f32 v129, v98, v99
    v_cvt_pk_bf16_f32 v130, v100, v101
    v_cvt_pk_bf16_f32 v131, v102, v103
    v_cvt_pk_bf16_f32 v132, v104, v105
    v_cvt_pk_bf16_f32 v133, v106, v107
    v_cvt_pk_bf16_f32 v134, v108, v109
    v_cvt_pk_bf16_f32 v135, v110, v111
    buffer_load_dwordx4 a[116:119], v1, s[12:15], s18 offen offset:1024 sc1
    s_waitcnt lgkmcnt(5)
    v_mfma_f32_32x32x16_bf16 v[232:247], v[136:139], v[112:115], 0
    s_waitcnt lgkmcnt(4)
    v_mfma_f32_32x32x16_bf16 v[232:247], v[140:143], v[116:119], v[232:247]
    buffer_load_dwordx4 a[120:123], v1, s[12:15], s18 offen offset:2048 sc1
    s_waitcnt lgkmcnt(3)
    v_mfma_f32_32x32x16_bf16 v[232:247], v[144:147], v[120:123], v[232:247]
    s_waitcnt lgkmcnt(2)
    v_mfma_f32_32x32x16_bf16 v[232:247], v[148:151], v[124:127], v[232:247]
    buffer_load_dwordx4 a[124:127], v1, s[12:15], s18 offen offset:3072 sc1
    s_waitcnt lgkmcnt(1)
    v_mfma_f32_32x32x16_bf16 v[232:247], v[152:155], v[128:131], v[232:247]
    s_waitcnt lgkmcnt(0)
    v_mfma_f32_32x32x16_bf16 v[232:247], v[156:159], v[132:135], v[232:247]
    s_add_u32 s18, s17, 315392
    s_waitcnt vmcnt(19)
    buffer_load_dwordx4 a[128:131], v1, s[12:15], s18 offen offset:0 sc1
    v_mov_b32 v10, 120
    buffer_load_dword v11, v10, s[56:59], 0 offen sc1
    s_lshl_b32 s19, s16, 12
    v_add_u32 v248, s19, v1
    s_nop 4
    ds_write_b128 v248, v[232:235] offset:49152
    ds_write_b128 v248, v[236:239] offset:50176
    ds_write_b128 v248, v[240:243] offset:51200
    ds_write_b128 v248, v[244:247] offset:52224
    s_waitcnt vmcnt(19)
    buffer_load_dwordx4 a[132:135], v1, s[12:15], s18 offen offset:1024 sc1
    s_waitcnt vmcnt(19)
    buffer_load_dwordx4 a[136:139], v1, s[12:15], s18 offen offset:2048 sc1
    s_waitcnt vmcnt(19)
    buffer_load_dwordx4 a[140:143], v1, s[12:15], s18 offen offset:3072 sc1
    s_add_u32 s18, s17, 319488
    s_waitcnt vmcnt(19)
    buffer_load_dwordx4 a[144:147], v1, s[12:15], s18 offen offset:0 sc1
    s_waitcnt vmcnt(19)
    buffer_load_dwordx4 a[148:151], v1, s[12:15], s18 offen offset:1024 sc1
    s_waitcnt vmcnt(19)
    buffer_load_dwordx4 a[152:155], v1, s[12:15], s18 offen offset:2048 sc1
    s_waitcnt lgkmcnt(0)
    s_barrier
    ds_read_b128 v[160:163], v1 offset:49152
    ds_read_b128 v[164:167], v1 offset:50176
    ds_read_b128 v[168:171], v1 offset:51200
    ds_read_b128 v[172:175], v1 offset:52224
    ds_read_b128 v[176:179], v1 offset:53248
    ds_read_b128 v[180:183], v1 offset:54272
    ds_read_b128 v[184:187], v1 offset:55296
    ds_read_b128 v[188:191], v1 offset:56320
    ds_read_b128 v[192:195], v1 offset:57344
    ds_read_b128 v[196:199], v1 offset:58368
    ds_read_b128 v[200:203], v1 offset:59392
    ds_read_b128 v[204:207], v1 offset:60416
    ds_read_b128 v[208:211], v1 offset:61440
    s_waitcnt vmcnt(19)
    buffer_load_dwordx4 a[156:159], v1, s[12:15], s18 offen offset:3072 sc1
    ds_read_b128 v[212:215], v1 offset:62464
    ds_read_b128 v[216:219], v1 offset:63488
    ds_read_b128 v[220:223], v1 offset:64512
    ds_read_b64_tr_b16 v[136:137], v8 offset:0
    ds_read_b64_tr_b16 v[138:139], v8 offset:128
    ds_read_b64_tr_b16 v[140:141], v8 offset:256
    ds_read_b64_tr_b16 v[142:143], v8 offset:384
    ds_read_b64_tr_b16 v[144:145], v8 offset:2048
    ds_read_b64_tr_b16 v[146:147], v8 offset:2176
    ds_read_b64_tr_b16 v[148:149], v8 offset:2304
    ds_read_b64_tr_b16 v[150:151], v8 offset:2432
    ds_read_b64_tr_b16 v[152:153], v8 offset:4096
    ds_read_b64_tr_b16 v[154:155], v8 offset:4224
    ds_read_b64_tr_b16 v[156:157], v8 offset:4352
    ds_read_b64_tr_b16 v[158:159], v8 offset:4480
    s_add_u32 s18, s17, 323584
    s_waitcnt vmcnt(19)
    buffer_load_dwordx4 a[160:163], v1, s[12:15], s18 offen offset:0 sc1
    s_waitcnt lgkmcnt(12)
    v_pk_add_f32 v[232:233], v[160:161], v[176:177]
    v_pk_add_f32 v[192:193], v[192:193], v[208:209]
    v_pk_add_f32 v[234:235], v[162:163], v[178:179]
    v_pk_add_f32 v[194:195], v[194:195], v[210:211]
    v_pk_add_f32 v[236:237], v[164:165], v[180:181]
    v_pk_add_f32 v[196:197], v[196:197], v[212:213]
    v_pk_add_f32 v[238:239], v[166:167], v[182:183]
    v_pk_add_f32 v[198:199], v[198:199], v[214:215]
    v_pk_add_f32 v[240:241], v[168:169], v[184:185]
    v_pk_add_f32 v[200:201], v[200:201], v[216:217]
    v_pk_add_f32 v[242:243], v[170:171], v[186:187]
    v_pk_add_f32 v[202:203], v[202:203], v[218:219]
    v_pk_add_f32 v[244:245], v[172:173], v[188:189]
    v_pk_add_f32 v[204:205], v[204:205], v[220:221]
    s_waitcnt vmcnt(19)
    buffer_load_dwordx4 a[164:167], v1, s[12:15], s18 offen offset:1024 sc1
    v_pk_add_f32 v[246:247], v[174:175], v[190:191]
    v_pk_add_f32 v[206:207], v[206:207], v[222:223]
    v_pk_add_f32 v[232:233], v[232:233], v[192:193]
    v_pk_add_f32 v[234:235], v[234:235], v[194:195]
    v_pk_add_f32 v[236:237], v[236:237], v[196:197]
    v_pk_add_f32 v[238:239], v[238:239], v[198:199]
    v_pk_add_f32 v[240:241], v[240:241], v[200:201]
    v_pk_add_f32 v[242:243], v[242:243], v[202:203]
    v_pk_add_f32 v[244:245], v[244:245], v[204:205]
    v_pk_add_f32 v[246:247], v[246:247], v[206:207]
    v_cndmask_b32 v248, v232, v236, s[22:23]
    v_cndmask_b32 v249, v233, v237, s[22:23]
    v_cndmask_b32 v250, v234, v238, s[22:23]
    v_cndmask_b32 v251, v235, v239, s[22:23]
    v_cndmask_b32 v248, v248, v240, s[24:25]
    s_waitcnt vmcnt(19)
    buffer_load_dwordx4 a[168:171], v1, s[12:15], s18 offen offset:2048 sc1
    v_cndmask_b32 v249, v249, v241, s[24:25]
    v_cndmask_b32 v250, v250, v242, s[24:25]
    v_cndmask_b32 v251, v251, v243, s[24:25]
    v_cndmask_b32 v248, v248, v244, s[26:27]
    v_cndmask_b32 v249, v249, v245, s[26:27]
    v_cndmask_b32 v250, v250, v246, s[26:27]
    v_cndmask_b32 v251, v251, v247, s[26:27]
    v_mov_b32 v252, s40
    v_cndmask_b32 v251, v251, v252, s[28:29]
    v_max3_f32 v252, v248, v249, v250
    v_max_f32 v252, v252, v251
    v_mov_b32 v253, v252
    s_nop 1
    v_permlane32_swap_b32 v252, v253
    s_waitcnt vmcnt(19)
    buffer_load_dwordx4 a[172:175], v1, s[12:15], s18 offen offset:3072 sc1
    v_max_f32 v252, v252, v253
    v_sub_f32 v248, v248, v252
    v_sub_f32 v249, v249, v252
    v_sub_f32 v250, v250, v252
    v_sub_f32 v251, v251, v252
    v_exp_f32 v248, v248
    v_exp_f32 v249, v249
    v_exp_f32 v250, v250
    v_exp_f32 v251, v251
    v_add_f32 v252, v248, v249
    v_add_f32 v253, v250, v251
    s_add_u32 s18, s17, 327680
    s_waitcnt vmcnt(19)
    buffer_load_dwordx4 a[176:179], v1, s[12:15], s18 offen offset:0 sc1
    v_add_f32 v252, v252, v253
    v_mov_b32 v253, v252
    s_nop 1
    v_permlane32_swap_b32 v252, v253
    v_add_f32 v252, v252, v253
    v_rcp_f32 v252, v252
    s_nop 0
    v_mul_f32 v248, v248, v252
    v_mul_f32 v249, v249, v252
    v_mul_f32 v250, v250, v252
    v_mul_f32 v251, v251, v252
    v_cvt_pk_bf16_f32 v252, v248, v249
    v_cvt_pk_bf16_f32 v253, v250, v251
    s_waitcnt vmcnt(19)
    buffer_load_dwordx4 a[180:183], v1, s[12:15], s18 offen offset:1024 sc1
    v_cndmask_b32 v224, 0, v252, s[20:21]
    v_cndmask_b32 v225, 0, v253, s[20:21]
    v_cndmask_b32 v226, 0, v252, s[22:23]
    v_cndmask_b32 v227, 0, v253, s[22:23]
    v_cndmask_b32 v228, 0, v252, s[24:25]
    v_cndmask_b32 v229, 0, v253, s[24:25]
    v_cndmask_b32 v230, 0, v252, s[26:27]
    v_cndmask_b32 v231, 0, v253, s[26:27]
    s_waitcnt lgkmcnt(10)
    v_mfma_f32_32x32x16_bf16 v[64:79], v[136:139], v[224:227], 0
    s_waitcnt vmcnt(19)
    buffer_load_dwordx4 a[184:187], v1, s[12:15], s18 offen offset:2048 sc1
    s_waitcnt lgkmcnt(8)
    v_mfma_f32_32x32x16_bf16 v[64:79], v[140:143], v[228:231], v[64:79]
    s_waitcnt lgkmcnt(6)
    v_mfma_f32_32x32x16_bf16 v[80:95], v[144:147], v[224:227], 0
    s_waitcnt vmcnt(19)
    buffer_load_dwordx4 a[188:191], v1, s[12:15], s18 offen offset:3072 sc1
    s_waitcnt lgkmcnt(4)
    v_mfma_f32_32x32x16_bf16 v[80:95], v[148:151], v[228:231], v[80:95]
    s_waitcnt lgkmcnt(2)
    v_mfma_f32_32x32x16_bf16 v[96:111], v[152:155], v[224:227], 0
    s_add_u32 s18, s17, 331776
    s_waitcnt vmcnt(19)
    buffer_load_dwordx4 a[192:195], v1, s[12:15], s18 offen offset:0 sc1
    s_waitcnt lgkmcnt(0)
    v_mfma_f32_32x32x16_bf16 v[96:111], v[156:159], v[228:231], v[96:111]
    v_cvt_pk_bf16_f32 v112, v64, v65
    v_cvt_pk_bf16_f32 v113, v66, v67
    v_cvt_pk_bf16_f32 v114, v68, v69
    v_cvt_pk_bf16_f32 v115, v70, v71
    v_cvt_pk_bf16_f32 v116, v72, v73
    v_cvt_pk_bf16_f32 v117, v74, v75
    s_waitcnt vmcnt(19)
    buffer_load_dwordx4 a[196:199], v1, s[12:15], s18 offen offset:1024 sc1
    v_cvt_pk_bf16_f32 v118, v76, v77
    v_cvt_pk_bf16_f32 v119, v78, v79
    v_cvt_pk_bf16_f32 v120, v80, v81
    v_cvt_pk_bf16_f32 v121, v82, v83
    v_cvt_pk_bf16_f32 v122, v84, v85
    v_cvt_pk_bf16_f32 v123, v86, v87
    v_cvt_pk_bf16_f32 v124, v88, v89
    v_cvt_pk_bf16_f32 v125, v90, v91
    v_cvt_pk_bf16_f32 v126, v92, v93
    v_cvt_pk_bf16_f32 v127, v94, v95
    v_cvt_pk_bf16_f32 v128, v96, v97
    v_cvt_pk_bf16_f32 v129, v98, v99
    v_cvt_pk_bf16_f32 v130, v100, v101
    v_cvt_pk_bf16_f32 v131, v102, v103
    v_cvt_pk_bf16_f32 v132, v104, v105
    s_waitcnt vmcnt(19)
    buffer_load_dwordx4 a[200:203], v1, s[12:15], s18 offen offset:2048 sc1
    v_cvt_pk_bf16_f32 v133, v106, v107
    v_cvt_pk_bf16_f32 v134, v108, v109
    v_cvt_pk_bf16_f32 v135, v110, v111
    ds_write_b128 v9, v[112:115] offset:24576
    ds_write_b128 v9, v[116:119] offset:25600
    ds_write_b128 v9, v[120:123] offset:26624
    ds_write_b128 v9, v[124:127] offset:27648
    ds_write_b128 v9, v[128:131] offset:28672
    ds_write_b128 v9, v[132:135] offset:29696
    s_waitcnt vmcnt(19)
    buffer_load_dwordx4 a[204:207], v1, s[12:15], s18 offen offset:3072 sc1
    s_add_u32 s18, s17, 335872
    s_waitcnt vmcnt(19)
    buffer_load_dwordx4 a[208:211], v1, s[12:15], s18 offen offset:0 sc1
    s_waitcnt vmcnt(19)
    buffer_load_dwordx4 a[212:215], v1, s[12:15], s18 offen offset:1024 sc1
    s_waitcnt vmcnt(19)
    buffer_load_dwordx4 a[216:219], v1, s[12:15], s18 offen offset:2048 sc1
    s_waitcnt vmcnt(19)
    buffer_load_dwordx4 a[220:223], v1, s[12:15], s18 offen offset:3072 sc1
    s_add_u32 s18, s17, 339968
    s_waitcnt vmcnt(19)
    buffer_load_dwordx4 a[224:227], v1, s[12:15], s18 offen offset:0 sc1
    s_waitcnt lgkmcnt(0)
    s_barrier
    ds_read_b128 v[136:139], v1 offset:24576
    ds_read_b128 v[140:143], v1 offset:25600
    ds_read_b128 v[144:147], v1 offset:26624
    ds_read_b128 v[148:151], v1 offset:27648
    ds_read_b128 v[152:155], v1 offset:28672
    ds_read_b128 v[156:159], v1 offset:29696
    ds_read_b128 v[160:163], v1 offset:30720
    ds_read_b128 v[164:167], v1 offset:31744
    ds_read_b128 v[168:171], v1 offset:32768
    ds_read_b128 v[172:175], v1 offset:33792
    ds_read_b128 v[176:179], v1 offset:34816
    ds_read_b128 v[180:183], v1 offset:35840
    ds_read_b128 v[184:187], v1 offset:36864
    s_waitcnt vmcnt(19)
    buffer_load_dwordx4 a[228:231], v1, s[12:15], s18 offen offset:1024 sc1
    ds_read_b128 v[188:191], v1 offset:37888
    ds_read_b128 v[192:195], v1 offset:38912
    ds_read_b128 v[196:199], v1 offset:39936
    ds_read_b128 v[200:203], v1 offset:40960
    ds_read_b128 v[204:207], v1 offset:41984
    ds_read_b128 v[208:211], v1 offset:43008
    ds_read_b128 v[212:215], v1 offset:44032
    ds_read_b128 v[216:219], v1 offset:45056
    ds_read_b128 v[220:223], v1 offset:46080
    ds_read_b128 v[224:227], v1 offset:47104
    ds_read_b128 v[228:231], v1 offset:48128
    s_waitcnt lgkmcnt(15)
    v_mfma_f32_32x32x16_bf16 v[64:79], a[48:51], v[136:139], 0
    s_waitcnt vmcnt(19)
    buffer_load_dwordx4 a[232:235], v1, s[12:15], s18 offen offset:2048 sc1
    v_mfma_f32_32x32x16_bf16 v[64:79], a[52:55], v[140:143], v[64:79]
    v_mfma_f32_32x32x16_bf16 v[64:79], a[56:59], v[144:147], v[64:79]
    s_waitcnt vmcnt(19)
    buffer_load_dwordx4 a[236:239], v1, s[12:15], s18 offen offset:3072 sc1
    v_mfma_f32_32x32x16_bf16 v[64:79], a[60:63], v[148:151], v[64:79]
    v_mfma_f32_32x32x16_bf16 v[64:79], a[64:67], v[152:155], v[64:79]
    s_add_u32 s18, s17, 344064
    s_waitcnt vmcnt(19)
    buffer_load_dwordx4 a[0:3], v1, s[12:15], s18 offen offset:0 sc1
    v_mfma_f32_32x32x16_bf16 v[64:79], a[68:71], v[156:159], v[64:79]
    v_mfma_f32_32x32x16_bf16 v[64:79], a[72:75], v[160:163], v[64:79]
    s_waitcnt vmcnt(19)
    buffer_load_dwordx4 a[4:7], v1, s[12:15], s18 offen offset:1024 sc1
    v_mfma_f32_32x32x16_bf16 v[64:79], a[76:79], v[164:167], v[64:79]
    v_mfma_f32_32x32x16_bf16 v[64:79], a[80:83], v[168:171], v[64:79]
    s_waitcnt vmcnt(19)
    buffer_load_dwordx4 a[8:11], v1, s[12:15], s18 offen offset:2048 sc1
    s_waitcnt lgkmcnt(14)
    v_mfma_f32_32x32x16_bf16 v[64:79], a[84:87], v[172:175], v[64:79]
    s_waitcnt lgkmcnt(13)
    v_mfma_f32_32x32x16_bf16 v[64:79], a[88:91], v[176:179], v[64:79]
    s_waitcnt vmcnt(19)
    buffer_load_dwordx4 a[12:15], v1, s[12:15], s18 offen offset:3072 sc1
    s_waitcnt lgkmcnt(12)
    v_mfma_f32_32x32x16_bf16 v[64:79], a[92:95], v[180:183], v[64:79]
    s_waitcnt lgkmcnt(11)
    v_mfma_f32_32x32x16_bf16 v[64:79], a[96:99], v[184:187], v[64:79]
    s_add_u32 s18, s17, 348160
    s_waitcnt vmcnt(19)
    buffer_load_dwordx4 a[16:19], v1, s[12:15], s18 offen offset:0 sc1
    s_waitcnt lgkmcnt(10)
    v_mfma_f32_32x32x16_bf16 v[64:79], a[100:103], v[188:191], v[64:79]
    s_waitcnt lgkmcnt(9)
    v_mfma_f32_32x32x16_bf16 v[64:79], a[104:107], v[192:195], v[64:79]
    s_waitcnt vmcnt(19)
    buffer_load_dwordx4 a[20:23], v1, s[12:15], s18 offen offset:1024 sc1
    s_waitcnt lgkmcnt(8)
    v_mfma_f32_32x32x16_bf16 v[64:79], a[108:111], v[196:199], v[64:79]
    s_waitcnt lgkmcnt(7)
    v_mfma_f32_32x32x16_bf16 v[64:79], a[112:115], v[200:203], v[64:79]
    s_waitcnt vmcnt(19)
    buffer_load_dwordx4 a[24:27], v1, s[12:15], s18 offen offset:2048 sc1
    s_waitcnt lgkmcnt(6)
    v_mfma_f32_32x32x16_bf16 v[64:79], a[116:119], v[204:207], v[64:79]
    s_waitcnt lgkmcnt(5)
    v_mfma_f32_32x32x16_bf16 v[64:79], a[120:123], v[208:211], v[64:79]
    s_waitcnt vmcnt(19)
    buffer_load_dwordx4 a[28:31], v1, s[12:15], s18 offen offset:3072 sc1
    s_waitcnt lgkmcnt(4)
    v_mfma_f32_32x32x16_bf16 v[64:79], a[124:127], v[212:215], v[64:79]
    s_waitcnt lgkmcnt(3)
    v_mfma_f32_32x32x16_bf16 v[64:79], a[128:131], v[216:219], v[64:79]
    s_add_u32 s18, s17, 352256
    s_waitcnt vmcnt(19)
    buffer_load_dwordx4 a[32:35], v1, s[12:15], s18 offen offset:0 sc1
    s_waitcnt lgkmcnt(2)
    v_mfma_f32_32x32x16_bf16 v[64:79], a[132:135], v[220:223], v[64:79]
    s_waitcnt lgkmcnt(1)
    v_mfma_f32_32x32x16_bf16 v[64:79], a[136:139], v[224:227], v[64:79]
    s_waitcnt vmcnt(19)
    buffer_load_dwordx4 a[36:39], v1, s[12:15], s18 offen offset:1024 sc1
    s_waitcnt lgkmcnt(0)
    v_mfma_f32_32x32x16_bf16 v[64:79], a[140:143], v[228:231], v[64:79]
    v_mfma_f32_32x32x16_bf16 v[80:95], a[144:147], v[136:139], 0
    s_waitcnt vmcnt(19)
    buffer_load_dwordx4 a[40:43], v1, s[12:15], s18 offen offset:2048 sc1
    v_mfma_f32_32x32x16_bf16 v[80:95], a[148:151], v[140:143], v[80:95]
    v_mfma_f32_32x32x16_bf16 v[80:95], a[152:155], v[144:147], v[80:95]
    s_waitcnt vmcnt(19)
    buffer_load_dwordx4 a[44:47], v1, s[12:15], s18 offen offset:3072 sc1
    v_mfma_f32_32x32x16_bf16 v[80:95], a[156:159], v[148:151], v[80:95]
    v_mfma_f32_32x32x16_bf16 v[80:95], a[160:163], v[152:155], v[80:95]
    s_add_u32 s18, s17, 356352
    s_waitcnt vmcnt(19)
    buffer_load_dwordx4 a[48:51], v1, s[12:15], s18 offen offset:0 sc1
    v_mfma_f32_32x32x16_bf16 v[80:95], a[164:167], v[156:159], v[80:95]
    v_mfma_f32_32x32x16_bf16 v[80:95], a[168:171], v[160:163], v[80:95]
    s_waitcnt vmcnt(19)
    buffer_load_dwordx4 a[52:55], v1, s[12:15], s18 offen offset:1024 sc1
    v_mfma_f32_32x32x16_bf16 v[80:95], a[172:175], v[164:167], v[80:95]
    v_mfma_f32_32x32x16_bf16 v[80:95], a[176:179], v[168:171], v[80:95]
    s_waitcnt vmcnt(19)
    buffer_load_dwordx4 a[56:59], v1, s[12:15], s18 offen offset:2048 sc1
    v_mfma_f32_32x32x16_bf16 v[80:95], a[180:183], v[172:175], v[80:95]
    v_mfma_f32_32x32x16_bf16 v[80:95], a[184:187], v[176:179], v[80:95]
    s_waitcnt vmcnt(19)
    buffer_load_dwordx4 a[60:63], v1, s[12:15], s18 offen offset:3072 sc1
    v_mfma_f32_32x32x16_bf16 v[80:95], a[188:191], v[180:183], v[80:95]
    v_mfma_f32_32x32x16_bf16 v[80:95], a[192:195], v[184:187], v[80:95]
    s_add_u32 s18, s17, 360448
    s_waitcnt vmcnt(19)
    buffer_load_dwordx4 a[64:67], v1, s[12:15], s18 offen offset:0 sc1
    v_mfma_f32_32x32x16_bf16 v[80:95], a[196:199], v[188:191], v[80:95]
    v_mfma_f32_32x32x16_bf16 v[80:95], a[200:203], v[192:195], v[80:95]
    s_waitcnt vmcnt(19)
    buffer_load_dwordx4 a[68:71], v1, s[12:15], s18 offen offset:1024 sc1
    v_mfma_f32_32x32x16_bf16 v[80:95], a[204:207], v[196:199], v[80:95]
    v_mfma_f32_32x32x16_bf16 v[80:95], a[208:211], v[200:203], v[80:95]
    s_waitcnt vmcnt(19)
    buffer_load_dwordx4 a[72:75], v1, s[12:15], s18 offen offset:2048 sc1
    v_mfma_f32_32x32x16_bf16 v[80:95], a[212:215], v[204:207], v[80:95]
    v_mfma_f32_32x32x16_bf16 v[80:95], a[216:219], v[208:211], v[80:95]
    s_waitcnt vmcnt(19)
    buffer_load_dwordx4 a[76:79], v1, s[12:15], s18 offen offset:3072 sc1
    v_mfma_f32_32x32x16_bf16 v[80:95], a[220:223], v[212:215], v[80:95]
    v_mfma_f32_32x32x16_bf16 v[80:95], a[224:227], v[216:219], v[80:95]
    s_add_u32 s18, s17, 364544
    s_waitcnt vmcnt(19)
    buffer_load_dwordx4 a[80:83], v1, s[12:15], s18 offen offset:0 sc1
    v_mfma_f32_32x32x16_bf16 v[80:95], a[228:231], v[220:223], v[80:95]
    v_mfma_f32_32x32x16_bf16 v[80:95], a[232:235], v[224:227], v[80:95]
    s_waitcnt vmcnt(19)
    buffer_load_dwordx4 a[84:87], v1, s[12:15], s18 offen offset:1024 sc1
    v_mfma_f32_32x32x16_bf16 v[80:95], a[236:239], v[228:231], v[80:95]
    v_mfma_f32_32x32x16_bf16 v[96:111], a[0:3], v[136:139], 0
    s_waitcnt vmcnt(19)
    buffer_load_dwordx4 a[88:91], v1, s[12:15], s18 offen offset:2048 sc1
    v_mfma_f32_32x32x16_bf16 v[96:111], a[4:7], v[140:143], v[96:111]
    v_mfma_f32_32x32x16_bf16 v[96:111], a[8:11], v[144:147], v[96:111]
    s_waitcnt vmcnt(19)
    buffer_load_dwordx4 a[92:95], v1, s[12:15], s18 offen offset:3072 sc1
    v_mfma_f32_32x32x16_bf16 v[96:111], a[12:15], v[148:151], v[96:111]
    s_waitcnt vmcnt(19)
    v_mfma_f32_32x32x16_bf16 v[96:111], a[16:19], v[152:155], v[96:111]
    v_readfirstlane_b32 s47, v11
    s_cmp_ge_u32 s47, 36
    s_cbranch_scc1 K1_PD_4
    v_mov_b32 v10, 120
    s_mov_b32 s46, 400000
K1_POLL_5:
    buffer_load_dword v11, v10, s[56:59], 0 offen sc1
    s_waitcnt vmcnt(0)
    v_readfirstlane_b32 s47, v11
    s_cmp_ge_u32 s47, 36
    s_cbranch_scc1 K1_PD_4
    s_sleep 8
    s_sub_u32 s46, s46, 1
    s_cmp_lg_u32 s46, 0
    s_cbranch_scc1 K1_POLL_5
K1_PD_4:
    s_add_u32 s18, s17, 589824
    buffer_load_dwordx4 a[96:99], v1, s[12:15], s18 offen offset:0 sc1
    s_waitcnt vmcnt(19)
    v_mfma_f32_32x32x16_bf16 v[96:111], a[20:23], v[156:159], v[96:111]
    s_waitcnt vmcnt(18)
    v_mfma_f32_32x32x16_bf16 v[96:111], a[24:27], v[160:163], v[96:111]
    buffer_load_dwordx4 a[100:103], v1, s[12:15], s18 offen offset:1024 sc1
    s_waitcnt vmcnt(18)
    v_mfma_f32_32x32x16_bf16 v[96:111], a[28:31], v[164:167], v[96:111]
    s_waitcnt vmcnt(17)
    v_mfma_f32_32x32x16_bf16 v[96:111], a[32:35], v[168:171], v[96:111]
    buffer_load_dwordx4 a[104:107], v1, s[12:15], s18 offen offset:2048 sc1
    s_waitcnt vmcnt(17)
    v_mfma_f32_32x32x16_bf16 v[96:111], a[36:39], v[172:175], v[96:111]
    s_waitcnt vmcnt(16)
    v_mfma_f32_32x32x16_bf16 v[96:111], a[40:43], v[176:179], v[96:111]
    buffer_load_dwordx4 a[108:111], v1, s[12:15], s18 offen offset:3072 sc1
    s_waitcnt vmcnt(16)
    v_mfma_f32_32x32x16_bf16 v[96:111], a[44:47], v[180:183], v[96:111]
    s_waitcnt vmcnt(15)
    v_mfma_f32_32x32x16_bf16 v[96:111], a[48:51], v[184:187], v[96:111]
    s_add_u32 s18, s17, 593920
    buffer_load_dwordx4 a[112:115], v1, s[12:15], s18 offen offset:0 sc1
    s_waitcnt vmcnt(15)
    v_mfma_f32_32x32x16_bf16 v[96:111], a[52:55], v[188:191], v[96:111]
    buffer_load_dwordx4 a[116:119], v1, s[12:15], s18 offen offset:1024 sc1
    s_waitcnt vmcnt(15)
    v_mfma_f32_32x32x16_bf16 v[96:111], a[56:59], v[192:195], v[96:111]
    buffer_load_dwordx4 a[120:123], v1, s[12:15], s18 offen offset:2048 sc1
    s_waitcnt vmcnt(15)
    v_mfma_f32_32x32x16_bf16 v[96:111], a[60:63], v[196:199], v[96:111]
    buffer_load_dwordx4 a[124:127], v1, s[12:15], s18 offen offset:3072 sc1
    s_waitcnt vmcnt(15)
    v_mfma_f32_32x32x16_bf16 v[96:111], a[64:67], v[200:203], v[96:111]
    s_add_u32 s18, s17, 598016
    buffer_load_dwordx4 a[128:131], v1, s[12:15], s18 offen offset:0 sc1
    s_waitcnt vmcnt(15)
    v_mfma_f32_32x32x16_bf16 v[96:111], a[68:71], v[204:207], v[96:111]
    buffer_load_dwordx4 a[132:135], v1, s[12:15], s18 offen offset:1024 sc1
    s_waitcnt vmcnt(15)
    v_mfma_f32_32x32x16_bf16 v[96:111], a[72:75], v[208:211], v[96:111]
    buffer_load_dwordx4 a[136:139], v1, s[12:15], s18 offen offset:2048 sc1
    s_waitcnt vmcnt(15)
    v_mfma_f32_32x32x16_bf16 v[96:111], a[76:79], v[212:215], v[96:111]
    buffer_load_dwordx4 a[140:143], v1, s[12:15], s18 offen offset:3072 sc1
    s_waitcnt vmcnt(15)
    v_mfma_f32_32x32x16_bf16 v[96:111], a[80:83], v[216:219], v[96:111]
    s_add_u32 s18, s17, 602112
    buffer_load_dwordx4 a[144:147], v1, s[12:15], s18 offen offset:0 sc1
    s_waitcnt vmcnt(15)
    v_mfma_f32_32x32x16_bf16 v[96:111], a[84:87], v[220:223], v[96:111]
    buffer_load_dwordx4 a[148:151], v1, s[12:15], s18 offen offset:1024 sc1
    s_waitcnt vmcnt(15)
    v_mfma_f32_32x32x16_bf16 v[96:111], a[88:91], v[224:227], v[96:111]
    buffer_load_dwordx4 a[152:155], v1, s[12:15], s18 offen offset:2048 sc1
    s_waitcnt vmcnt(15)
    v_mfma_f32_32x32x16_bf16 v[96:111], a[92:95], v[228:231], v[96:111]
    buffer_load_dwordx4 a[156:159], v1, s[12:15], s18 offen offset:3072 sc1
    v_pk_add_f32 v[64:65], v[64:65], v[16:17]
    v_pk_add_f32 v[66:67], v[66:67], v[18:19]
    v_pk_add_f32 v[68:69], v[68:69], v[20:21]
    v_pk_add_f32 v[70:71], v[70:71], v[22:23]
    v_pk_add_f32 v[72:73], v[72:73], v[24:25]
    v_pk_add_f32 v[74:75], v[74:75], v[26:27]
    v_pk_add_f32 v[76:77], v[76:77], v[28:29]
    v_pk_add_f32 v[78:79], v[78:79], v[30:31]
    v_pk_add_f32 v[80:81], v[80:81], v[32:33]
    v_pk_add_f32 v[82:83], v[82:83], v[34:35]
    v_pk_add_f32 v[84:85], v[84:85], v[36:37]
    v_pk_add_f32 v[86:87], v[86:87], v[38:39]
    v_pk_add_f32 v[88:89], v[88:89], v[40:41]
    v_pk_add_f32 v[90:91], v[90:91], v[42:43]
    v_pk_add_f32 v[92:93], v[92:93], v[44:45]
    s_add_u32 s18, s17, 606208
    buffer_load_dwordx4 a[160:163], v1, s[12:15], s18 offen offset:0 sc1
    v_pk_add_f32 v[94:95], v[94:95], v[46:47]
    v_pk_add_f32 v[96:97], v[96:97], v[48:49]
    v_pk_add_f32 v[98:99], v[98:99], v[50:51]
    v_pk_add_f32 v[100:101], v[100:101], v[52:53]
    v_pk_add_f32 v[102:103], v[102:103], v[54:55]
    v_pk_add_f32 v[104:105], v[104:105], v[56:57]
    v_pk_add_f32 v[106:107], v[106:107], v[58:59]
    v_pk_add_f32 v[108:109], v[108:109], v[60:61]
    v_pk_add_f32 v[110:111], v[110:111], v[62:63]
    v_cvt_pk_bf16_f32 v112, v64, v65
    v_cvt_pk_bf16_f32 v113, v66, v67
    v_cvt_pk_bf16_f32 v114, v68, v69
    v_cvt_pk_bf16_f32 v115, v70, v71
    v_cvt_pk_bf16_f32 v116, v72, v73
    v_cvt_pk_bf16_f32 v117, v74, v75
    buffer_load_dwordx4 a[164:167], v1, s[12:15], s18 offen offset:1024 sc1
    v_cvt_pk_bf16_f32 v118, v76, v77
    v_cvt_pk_bf16_f32 v119, v78, v79
    v_cvt_pk_bf16_f32 v120, v80, v81
    v_cvt_pk_bf16_f32 v121, v82, v83
    v_cvt_pk_bf16_f32 v122, v84, v85
    v_cvt_pk_bf16_f32 v123, v86, v87
    v_cvt_pk_bf16_f32 v124, v88, v89
    v_cvt_pk_bf16_f32 v125, v90, v91
    v_cvt_pk_bf16_f32 v126, v92, v93
    v_cvt_pk_bf16_f32 v127, v94, v95
    v_cvt_pk_bf16_f32 v128, v96, v97
    v_cvt_pk_bf16_f32 v129, v98, v99
    v_cvt_pk_bf16_f32 v130, v100, v101
    v_cvt_pk_bf16_f32 v131, v102, v103
    v_cvt_pk_bf16_f32 v132, v104, v105
    buffer_load_dwordx4 a[168:171], v1, s[12:15], s18 offen offset:2048 sc1
    v_cvt_pk_bf16_f32 v133, v106, v107
    v_cvt_pk_bf16_f32 v134, v108, v109
    v_cvt_pk_bf16_f32 v135, v110, v111
    ds_write_b64 v4, v[112:113] offset:0
    ds_write_b64 v4, v[114:115] offset:16
    ds_write_b64 v4, v[116:117] offset:32
    ds_write_b64 v4, v[118:119] offset:48
    ds_write_b64 v4, v[120:121] offset:64
    ds_write_b64 v4, v[122:123] offset:80
    ds_write_b64 v4, v[124:125] offset:96
    ds_write_b64 v4, v[126:127] offset:112
    ds_write_b64 v4, v[128:129] offset:128
    ds_write_b64 v4, v[130:131] offset:144
    ds_write_b64 v4, v[132:133] offset:160
    ds_write_b64 v4, v[134:135] offset:176
    buffer_load_dwordx4 a[172:175], v1, s[12:15], s18 offen offset:3072 sc1
    v_mov_b32 v248, 0
    v_mov_b32 v249, 0
    v_mov_b32 v250, 0
    v_mov_b32 v251, 0
    v_dot2c_f32_bf16 v248, s35, v112
    v_dot2c_f32_bf16 v250, v112, v112
    v_dot2c_f32_bf16 v249, s35, v113
    v_dot2c_f32_bf16 v251, v113, v113
    v_dot2c_f32_bf16 v248, s35, v114
    v_dot2c_f32_bf16 v250, v114, v114
    v_dot2c_f32_bf16 v249, s35, v115
    v_dot2c_f32_bf16 v251, v115, v115
    v_dot2c_f32_bf16 v248, s35, v116
    v_dot2c_f32_bf16 v250, v116, v116
    v_dot2c_f32_bf16 v249, s35, v117
    s_add_u32 s18, s17, 610304
    s_waitcnt vmcnt(19)
    buffer_load_dwordx4 a[176:179], v1, s[12:15], s18 offen offset:0 sc1
    v_dot2c_f32_bf16 v251, v117, v117
    v_dot2c_f32_bf16 v248, s35, v118
    v_dot2c_f32_bf16 v250, v118, v118
    v_dot2c_f32_bf16 v249, s35, v119
    v_dot2c_f32_bf16 v251, v119, v119
    v_dot2c_f32_bf16 v248, s35, v120
    v_dot2c_f32_bf16 v250, v120, v120
    v_dot2c_f32_bf16 v249, s35, v121
    v_dot2c_f32_bf16 v251, v121, v121
    v_dot2c_f32_bf16 v248, s35, v122
    v_dot2c_f32_bf16 v250, v122, v122
    v_dot2c_f32_bf16 v249, s35, v123
    v_dot2c_f32_bf16 v251, v123, v123
    v_dot2c_f32_bf16 v248, s35, v124
    v_dot2c_f32_bf16 v250, v124, v124
    s_waitcnt vmcnt(19)
    buffer_load_dwordx4 a[180:183], v1, s[12:15], s18 offen offset:1024 sc1
    v_dot2c_f32_bf16 v249, s35, v125
    v_dot2c_f32_bf16 v251, v125, v125
    v_dot2c_f32_bf16 v248, s35, v126
    v_dot2c_f32_bf16 v250, v126, v126
    v_dot2c_f32_bf16 v249, s35, v127
    v_dot2c_f32_bf16 v251, v127, v127
    v_dot2c_f32_bf16 v248, s35, v128
    v_dot2c_f32_bf16 v250, v128, v128
    v_dot2c_f32_bf16 v249, s35, v129
    v_dot2c_f32_bf16 v251, v129, v129
    v_dot2c_f32_bf16 v248, s35, v130
    v_dot2c_f32_bf16 v250, v130, v130
    v_dot2c_f32_bf16 v249, s35, v131
    v_dot2c_f32_bf16 v251, v131, v131
    v_dot2c_f32_bf16 v248, s35, v132
    s_waitcnt vmcnt(19)
    buffer_load_dwordx4 a[184:187], v1, s[12:15], s18 offen offset:2048 sc1
    v_dot2c_f32_bf16 v250, v132, v132
    v_dot2c_f32_bf16 v249, s35, v133
    v_dot2c_f32_bf16 v251, v133, v133
    v_dot2c_f32_bf16 v248, s35, v134
    v_dot2c_f32_bf16 v250, v134, v134
    v_dot2c_f32_bf16 v249, s35, v135
    v_dot2c_f32_bf16 v251, v135, v135
    s_nop 1
    v_add_f32 v248, v248, v249
    v_add_f32 v249, v250, v251
    v_mov_b32 v250, v248
    v_mov_b32 v251, v249
    s_nop 0
    v_permlane32_swap_b32 v248, v250
    s_waitcnt vmcnt(19)
    buffer_load_dwordx4 a[188:191], v1, s[12:15], s18 offen offset:3072 sc1
    v_permlane32_swap_b32 v249, v251
    v_add_f32 v248, v248, v250
    v_add_f32 v249, v249, v251
    ds_write_b64 v6, v[248:249] offset:1024
    s_add_u32 s18, s17, 614400
    s_waitcnt vmcnt(19)
    buffer_load_dwordx4 a[192:195], v1, s[12:15], s18 offen offset:0 sc1
    s_waitcnt vmcnt(19)
    buffer_load_dwordx4 a[196:199], v1, s[12:15], s18 offen offset:1024 sc1
    s_waitcnt vmcnt(19)
    buffer_load_dwordx4 a[200:203], v1, s[12:15], s18 offen offset:2048 sc1
    s_waitcnt vmcnt(19)
    buffer_load_dwordx4 a[204:207], v1, s[12:15], s18 offen offset:3072 sc1
    s_add_u32 s18, s17, 618496
    s_waitcnt vmcnt(19)
    buffer_load_dwordx4 a[208:211], v1, s[12:15], s18 offen offset:0 sc1
    s_waitcnt vmcnt(19)
    buffer_load_dwordx4 a[212:215], v1, s[12:15], s18 offen offset:1024 sc1
    s_waitcnt lgkmcnt(0)
    s_barrier
    ds_read_b64 v[232:233], v7 offset:1024
    ds_read_b64 v[234:235], v7 offset:1280
    ds_read_b64 v[236:237], v7 offset:1536
    ds_read_b64 v[238:239], v7 offset:1792
    s_waitcnt lgkmcnt(0)
    v_pk_add_f32 v[248:249], v[232:233], v[234:235]
    v_pk_add_f32 v[250:251], v[236:237], v[238:239]
    v_pk_add_f32 v[248:249], v[248:249], v[250:251]
    v_mul_f32 v248, s36, v248
    v_mul_f32 v249, s36, v249
    v_fma_f32 v249, -v248, v248, v249
    v_max_f32 v249, 0, v249
    v_add_f32 v249, s37, v249
    s_waitcnt vmcnt(19)
    buffer_load_dwordx4 a[216:219], v1, s[12:15], s18 offen offset:2048 sc1
    v_rsq_f32 v250, v249
    s_nop 0
    v_mul_f32 v252, v248, v250
    v_pk_fma_f32 v[248:249], v[64:65], v[250:251], v[252:253] op_sel_hi:[1,0,0] neg_lo:[0,0,1] neg_hi:[0,0,1]
    v_cvt_pk_bf16_f32 v112, v248, v249
    v_pk_fma_f32 v[254:255], v[66:67], v[250:251], v[252:253] op_sel_hi:[1,0,0] neg_lo:[0,0,1] neg_hi:[0,0,1]
    v_cvt_pk_bf16_f32 v113, v254, v255
    v_pk_fma_f32 v[248:249], v[68:69], v[250:251], v[252:253] op_sel_hi:[1,0,0] neg_lo:[0,0,1] neg_hi:[0,0,1]
    v_cvt_pk_bf16_f32 v114, v248, v249
    v_pk_fma_f32 v[254:255], v[70:71], v[250:251], v[252:253] op_sel_hi:[1,0,0] neg_lo:[0,0,1] neg_hi:[0,0,1]
    v_cvt_pk_bf16_f32 v115, v254, v255
    v_pk_fma_f32 v[248:249], v[72:73], v[250:251], v[252:253] op_sel_hi:[1,0,0] neg_lo:[0,0,1] neg_hi:[0,0,1]
    v_cvt_pk_bf16_f32 v116, v248, v249
    v_pk_fma_f32 v[254:255], v[74:75], v[250:251], v[252:253] op_sel_hi:[1,0,0] neg_lo:[0,0,1] neg_hi:[0,0,1]
    s_waitcnt vmcnt(19)
    buffer_load_dwordx4 a[220:223], v1, s[12:15], s18 offen offset:3072 sc1
    v_cvt_pk_bf16_f32 v117, v254, v255
    v_pk_fma_f32 v[248:249], v[76:77], v[250:251], v[252:253] op_sel_hi:[1,0,0] neg_lo:[0,0,1] neg_hi:[0,0,1]
    v_cvt_pk_bf16_f32 v118, v248, v249
    v_pk_fma_f32 v[254:255], v[78:79], v[250:251], v[252:253] op_sel_hi:[1,0,0] neg_lo:[0,0,1] neg_hi:[0,0,1]
    v_cvt_pk_bf16_f32 v119, v254, v255
    v_pk_fma_f32 v[248:249], v[80:81], v[250:251], v[252:253] op_sel_hi:[1,0,0] neg_lo:[0,0,1] neg_hi:[0,0,1]
    v_cvt_pk_bf16_f32 v120, v248, v249
    v_pk_fma_f32 v[254:255], v[82:83], v[250:251], v[252:253] op_sel_hi:[1,0,0] neg_lo:[0,0,1] neg_hi:[0,0,1]
    v_cvt_pk_bf16_f32 v121, v254, v255
    v_pk_fma_f32 v[248:249], v[84:85], v[250:251], v[252:253] op_sel_hi:[1,0,0] neg_lo:[0,0,1] neg_hi:[0,0,1]
    v_cvt_pk_bf16_f32 v122, v248, v249
    v_pk_fma_f32 v[254:255], v[86:87], v[250:251], v[252:253] op_sel_hi:[1,0,0] neg_lo:[0,0,1] neg_hi:[0,0,1]
    v_cvt_pk_bf16_f32 v123, v254, v255
    v_pk_fma_f32 v[248:249], v[88:89], v[250:251], v[252:253] op_sel_hi:[1,0,0] neg_lo:[0,0,1] neg_hi:[0,0,1]
    v_cvt_pk_bf16_f32 v124, v248, v249
    s_add_u32 s18, s17, 622592
    s_waitcnt vmcnt(19)
    buffer_load_dwordx4 a[224:227], v1, s[12:15], s18 offen offset:0 sc1
    v_pk_fma_f32 v[254:255], v[90:91], v[250:251], v[252:253] op_sel_hi:[1,0,0] neg_lo:[0,0,1] neg_hi:[0,0,1]
    v_cvt_pk_bf16_f32 v125, v254, v255
    v_pk_fma_f32 v[248:249], v[92:93], v[250:251], v[252:253] op_sel_hi:[1,0,0] neg_lo:[0,0,1] neg_hi:[0,0,1]
    v_cvt_pk_bf16_f32 v126, v248, v249
    v_pk_fma_f32 v[254:255], v[94:95], v[250:251], v[252:253] op_sel_hi:[1,0,0] neg_lo:[0,0,1] neg_hi:[0,0,1]
    v_cvt_pk_bf16_f32 v127, v254, v255
    v_pk_fma_f32 v[248:249], v[96:97], v[250:251], v[252:253] op_sel_hi:[1,0,0] neg_lo:[0,0,1] neg_hi:[0,0,1]
    v_cvt_pk_bf16_f32 v128, v248, v249
    v_pk_fma_f32 v[254:255], v[98:99], v[250:251], v[252:253] op_sel_hi:[1,0,0] neg_lo:[0,0,1] neg_hi:[0,0,1]
    v_cvt_pk_bf16_f32 v129, v254, v255
    v_pk_fma_f32 v[248:249], v[100:101], v[250:251], v[252:253] op_sel_hi:[1,0,0] neg_lo:[0,0,1] neg_hi:[0,0,1]
    v_cvt_pk_bf16_f32 v130, v248, v249
    v_pk_fma_f32 v[254:255], v[102:103], v[250:251], v[252:253] op_sel_hi:[1,0,0] neg_lo:[0,0,1] neg_hi:[0,0,1]
    v_cvt_pk_bf16_f32 v131, v254, v255
    v_pk_fma_f32 v[248:249], v[104:105], v[250:251], v[252:253] op_sel_hi:[1,0,0] neg_lo:[0,0,1] neg_hi:[0,0,1]
    s_waitcnt vmcnt(19)
    buffer_load_dwordx4 a[228:231], v1, s[12:15], s18 offen offset:1024 sc1
    v_cvt_pk_bf16_f32 v132, v248, v249
    v_pk_fma_f32 v[254:255], v[106:107], v[250:251], v[252:253] op_sel_hi:[1,0,0] neg_lo:[0,0,1] neg_hi:[0,0,1]
    v_cvt_pk_bf16_f32 v133, v254, v255
    v_pk_fma_f32 v[248:249], v[108:109], v[250:251], v[252:253] op_sel_hi:[1,0,0] neg_lo:[0,0,1] neg_hi:[0,0,1]
    v_cvt_pk_bf16_f32 v134, v248, v249
    v_pk_fma_f32 v[254:255], v[110:111], v[250:251], v[252:253] op_sel_hi:[1,0,0] neg_lo:[0,0,1] neg_hi:[0,0,1]
    v_cvt_pk_bf16_f32 v135, v254, v255
    ds_write_b128 v3, v[112:115] offset:25088
    ds_write_b128 v3, v[116:119] offset:25120
    ds_write_b128 v3, v[120:123] offset:25152
    ds_write_b128 v3, v[124:127] offset:25184
    ds_write_b128 v3, v[128:131] offset:25216
    ds_write_b128 v3, v[132:135] offset:25248
    ds_write_b128 v9, v[112:115] offset:0
    ds_write_b128 v9, v[116:119] offset:1024
    s_waitcnt vmcnt(19)
    buffer_load_dwordx4 a[232:235], v1, s[12:15], s18 offen offset:2048 sc1
    ds_write_b128 v9, v[120:123] offset:2048
    ds_write_b128 v9, v[124:127] offset:3072
    ds_write_b128 v9, v[128:131] offset:4096
    ds_write_b128 v9, v[132:135] offset:5120
    s_waitcnt vmcnt(19)
    buffer_load_dwordx4 a[236:239], v1, s[12:15], s18 offen offset:3072 sc1
    s_add_u32 s18, s17, 626688
    s_waitcnt vmcnt(19)
    buffer_load_dwordx4 a[0:3], v1, s[12:15], s18 offen offset:0 sc1
    s_waitcnt vmcnt(19)
    buffer_load_dwordx4 a[4:7], v1, s[12:15], s18 offen offset:1024 sc1
    s_waitcnt vmcnt(19)
    buffer_load_dwordx4 a[8:11], v1, s[12:15], s18 offen offset:2048 sc1
    s_waitcnt vmcnt(19)
    buffer_load_dwordx4 a[12:15], v1, s[12:15], s18 offen offset:3072 sc1
    s_add_u32 s18, s17, 630784
    s_waitcnt vmcnt(19)
    buffer_load_dwordx4 a[16:19], v1, s[12:15], s18 offen offset:0 sc1
    s_waitcnt lgkmcnt(0)
    s_barrier
    ds_read_b128 v[136:139], v1 offset:0
    ds_read_b128 v[140:143], v1 offset:1024
    ds_read_b128 v[144:147], v1 offset:2048
    ds_read_b128 v[148:151], v1 offset:3072
    ds_read_b128 v[152:155], v1 offset:4096
    ds_read_b128 v[156:159], v1 offset:5120
    ds_read_b128 v[160:163], v1 offset:6144
    ds_read_b128 v[164:167], v1 offset:7168
    ds_read_b128 v[168:171], v1 offset:8192
    ds_read_b128 v[172:175], v1 offset:9216
    ds_read_b128 v[176:179], v1 offset:10240
    ds_read_b128 v[180:183], v1 offset:11264
    ds_read_b128 v[184:187], v1 offset:12288
    s_waitcnt vmcnt(19)
    buffer_load_dwordx4 a[20:23], v1, s[12:15], s18 offen offset:1024 sc1
    ds_read_b128 v[188:191], v1 offset:13312
    ds_read_b128 v[192:195], v1 offset:14336
    ds_read_b128 v[196:199], v1 offset:15360
    ds_read_b128 v[200:203], v1 offset:16384
    ds_read_b128 v[204:207], v1 offset:17408
    ds_read_b128 v[208:211], v1 offset:18432
    ds_read_b128 v[212:215], v1 offset:19456
    ds_read_b128 v[216:219], v1 offset:20480
    ds_read_b128 v[220:223], v1 offset:21504
    ds_read_b128 v[224:227], v1 offset:22528
    ds_read_b128 v[228:231], v1 offset:23552
    s_waitcnt lgkmcnt(15)
    v_mfma_f32_32x32x16_bf16 v[64:79], a[96:99], v[136:139], 0
    s_waitcnt vmcnt(19)
    buffer_load_dwordx4 a[24:27], v1, s[12:15], s18 offen offset:2048 sc1
    v_mfma_f32_32x32x16_bf16 v[64:79], a[100:103], v[140:143], v[64:79]
    v_mfma_f32_32x32x16_bf16 v[64:79], a[104:107], v[144:147], v[64:79]
    s_waitcnt vmcnt(19)
    buffer_load_dwordx4 a[28:31], v1, s[12:15], s18 offen offset:3072 sc1
    v_mfma_f32_32x32x16_bf16 v[64:79], a[108:111], v[148:151], v[64:79]
    v_mfma_f32_32x32x16_bf16 v[64:79], a[112:115], v[152:155], v[64:79]
    s_add_u32 s18, s17, 634880
    s_waitcnt vmcnt(19)
    buffer_load_dwordx4 a[32:35], v1, s[12:15], s18 offen offset:0 sc1
    v_mfma_f32_32x32x16_bf16 v[64:79], a[116:119], v[156:159], v[64:79]
    v_mfma_f32_32x32x16_bf16 v[64:79], a[120:123], v[160:163], v[64:79]
    s_waitcnt vmcnt(19)
    buffer_load_dwordx4 a[36:39], v1, s[12:15], s18 offen offset:1024 sc1
    v_mfma_f32_32x32x16_bf16 v[64:79], a[124:127], v[164:167], v[64:79]
    v_mfma_f32_32x32x16_bf16 v[64:79], a[128:131], v[168:171], v[64:79]
    s_waitcnt vmcnt(19)
    buffer_load_dwordx4 a[40:43], v1, s[12:15], s18 offen offset:2048 sc1
    s_waitcnt lgkmcnt(14)
    v_mfma_f32_32x32x16_bf16 v[64:79], a[132:135], v[172:175], v[64:79]
    s_waitcnt lgkmcnt(13)
    v_mfma_f32_32x32x16_bf16 v[64:79], a[136:139], v[176:179], v[64:79]
    s_waitcnt vmcnt(19)
    buffer_load_dwordx4 a[44:47], v1, s[12:15], s18 offen offset:3072 sc1
    s_waitcnt lgkmcnt(12)
    v_mfma_f32_32x32x16_bf16 v[64:79], a[140:143], v[180:183], v[64:79]
    s_waitcnt lgkmcnt(11)
    v_mfma_f32_32x32x16_bf16 v[64:79], a[144:147], v[184:187], v[64:79]
    s_add_u32 s18, s17, 638976
    s_waitcnt vmcnt(19)
    buffer_load_dwordx4 a[48:51], v1, s[12:15], s18 offen offset:0 sc1
    s_waitcnt lgkmcnt(10)
    v_mfma_f32_32x32x16_bf16 v[64:79], a[148:151], v[188:191], v[64:79]
    s_waitcnt lgkmcnt(9)
    v_mfma_f32_32x32x16_bf16 v[64:79], a[152:155], v[192:195], v[64:79]
    s_waitcnt vmcnt(19)
    buffer_load_dwordx4 a[52:55], v1, s[12:15], s18 offen offset:1024 sc1
    s_waitcnt lgkmcnt(8)
    v_mfma_f32_32x32x16_bf16 v[64:79], a[156:159], v[196:199], v[64:79]
    s_waitcnt lgkmcnt(7)
    v_mfma_f32_32x32x16_bf16 v[64:79], a[160:163], v[200:203], v[64:79]
    s_waitcnt vmcnt(19)
    buffer_load_dwordx4 a[56:59], v1, s[12:15], s18 offen offset:2048 sc1
    s_waitcnt lgkmcnt(6)
    v_mfma_f32_32x32x16_bf16 v[64:79], a[164:167], v[204:207], v[64:79]
    s_waitcnt lgkmcnt(5)
    v_mfma_f32_32x32x16_bf16 v[64:79], a[168:171], v[208:211], v[64:79]
    s_waitcnt vmcnt(19)
    buffer_load_dwordx4 a[60:63], v1, s[12:15], s18 offen offset:3072 sc1
    s_waitcnt lgkmcnt(4)
    v_mfma_f32_32x32x16_bf16 v[64:79], a[172:175], v[212:215], v[64:79]
    s_waitcnt lgkmcnt(3)
    v_mfma_f32_32x32x16_bf16 v[64:79], a[176:179], v[216:219], v[64:79]
    s_add_u32 s18, s17, 643072
    s_waitcnt vmcnt(19)
    buffer_load_dwordx4 a[64:67], v1, s[12:15], s18 offen offset:0 sc1
    s_waitcnt lgkmcnt(2)
    v_mfma_f32_32x32x16_bf16 v[64:79], a[180:183], v[220:223], v[64:79]
    s_waitcnt lgkmcnt(1)
    v_mfma_f32_32x32x16_bf16 v[64:79], a[184:187], v[224:227], v[64:79]
    s_waitcnt vmcnt(19)
    buffer_load_dwordx4 a[68:71], v1, s[12:15], s18 offen offset:1024 sc1
    s_waitcnt lgkmcnt(0)
    v_mfma_f32_32x32x16_bf16 v[64:79], a[188:191], v[228:231], v[64:79]
    v_mfma_f32_32x32x16_bf16 v[80:95], a[192:195], v[136:139], 0
    s_waitcnt vmcnt(19)
    buffer_load_dwordx4 a[72:75], v1, s[12:15], s18 offen offset:2048 sc1
    v_mfma_f32_32x32x16_bf16 v[80:95], a[196:199], v[140:143], v[80:95]
    v_mfma_f32_32x32x16_bf16 v[80:95], a[200:203], v[144:147], v[80:95]
    s_waitcnt vmcnt(19)
    buffer_load_dwordx4 a[76:79], v1, s[12:15], s18 offen offset:3072 sc1
    v_mfma_f32_32x32x16_bf16 v[80:95], a[204:207], v[148:151], v[80:95]
    v_mfma_f32_32x32x16_bf16 v[80:95], a[208:211], v[152:155], v[80:95]
    s_add_u32 s18, s17, 647168
    s_waitcnt vmcnt(19)
    buffer_load_dwordx4 a[80:83], v1, s[12:15], s18 offen offset:0 sc1
    v_mfma_f32_32x32x16_bf16 v[80:95], a[212:215], v[156:159], v[80:95]
    v_mfma_f32_32x32x16_bf16 v[80:95], a[216:219], v[160:163], v[80:95]
    s_waitcnt vmcnt(19)
    buffer_load_dwordx4 a[84:87], v1, s[12:15], s18 offen offset:1024 sc1
    v_mfma_f32_32x32x16_bf16 v[80:95], a[220:223], v[164:167], v[80:95]
    v_mfma_f32_32x32x16_bf16 v[80:95], a[224:227], v[168:171], v[80:95]
    s_waitcnt vmcnt(19)
    buffer_load_dwordx4 a[88:91], v1, s[12:15], s18 offen offset:2048 sc1
    v_mfma_f32_32x32x16_bf16 v[80:95], a[228:231], v[172:175], v[80:95]
    v_mfma_f32_32x32x16_bf16 v[80:95], a[232:235], v[176:179], v[80:95]
    s_waitcnt vmcnt(19)
    buffer_load_dwordx4 a[92:95], v1, s[12:15], s18 offen offset:3072 sc1
    v_mfma_f32_32x32x16_bf16 v[80:95], a[236:239], v[180:183], v[80:95]
    v_mfma_f32_32x32x16_bf16 v[80:95], a[0:3], v[184:187], v[80:95]
    s_add_u32 s18, s17, 651264
    s_waitcnt vmcnt(19)
    buffer_load_dwordx4 a[96:99], v1, s[12:15], s18 offen offset:0 sc1
    v_mfma_f32_32x32x16_bf16 v[80:95], a[4:7], v[188:191], v[80:95]
    v_mfma_f32_32x32x16_bf16 v[80:95], a[8:11], v[192:195], v[80:95]
    s_waitcnt vmcnt(19)
    buffer_load_dwordx4 a[100:103], v1, s[12:15], s18 offen offset:1024 sc1
    v_mfma_f32_32x32x16_bf16 v[80:95], a[12:15], v[196:199], v[80:95]
    v_mfma_f32_32x32x16_bf16 v[80:95], a[16:19], v[200:203], v[80:95]
    s_waitcnt vmcnt(19)
    buffer_load_dwordx4 a[104:107], v1, s[12:15], s18 offen offset:2048 sc1
    v_mfma_f32_32x32x16_bf16 v[80:95], a[20:23], v[204:207], v[80:95]
    v_mfma_f32_32x32x16_bf16 v[80:95], a[24:27], v[208:211], v[80:95]
    s_waitcnt vmcnt(19)
    buffer_load_dwordx4 a[108:111], v1, s[12:15], s18 offen offset:3072 sc1
    v_mfma_f32_32x32x16_bf16 v[80:95], a[28:31], v[212:215], v[80:95]
    s_waitcnt vmcnt(19)
    v_mfma_f32_32x32x16_bf16 v[80:95], a[32:35], v[216:219], v[80:95]
    s_add_u32 s18, s17, 655360
    buffer_load_dwordx4 a[112:115], v1, s[12:15], s18 offen offset:0 sc1
    s_waitcnt vmcnt(19)
    v_mfma_f32_32x32x16_bf16 v[80:95], a[36:39], v[220:223], v[80:95]
    s_waitcnt vmcnt(18)
    v_mfma_f32_32x32x16_bf16 v[80:95], a[40:43], v[224:227], v[80:95]
    buffer_load_dwordx4 a[116:119], v1, s[12:15], s18 offen offset:1024 sc1
    s_waitcnt vmcnt(18)
    v_mfma_f32_32x32x16_bf16 v[80:95], a[44:47], v[228:231], v[80:95]
    s_waitcnt vmcnt(17)
    v_mfma_f32_32x32x16_bf16 v[96:111], a[48:51], v[136:139], 0
    buffer_load_dwordx4 a[120:123], v1, s[12:15], s18 offen offset:2048 sc1
    s_waitcnt vmcnt(17)
    v_mfma_f32_32x32x16_bf16 v[96:111], a[52:55], v[140:143], v[96:111]
    s_waitcnt vmcnt(16)
    v_mfma_f32_32x32x16_bf16 v[96:111], a[56:59], v[144:147], v[96:111]
    buffer_load_dwordx4 a[124:127], v1, s[12:15], s18 offen offset:3072 sc1
    s_waitcnt vmcnt(16)
    v_mfma_f32_32x32x16_bf16 v[96:111], a[60:63], v[148:151], v[96:111]
    s_waitcnt vmcnt(15)
    v_mfma_f32_32x32x16_bf16 v[96:111], a[64:67], v[152:155], v[96:111]
    s_add_u32 s18, s17, 659456
    buffer_load_dwordx4 a[128:131], v1, s[12:15], s18 offen offset:0 sc1
    s_waitcnt vmcnt(15)
    v_mfma_f32_32x32x16_bf16 v[96:111], a[68:71], v[156:159], v[96:111]
    buffer_load_dwordx4 a[132:135], v1, s[12:15], s18 offen offset:1024 sc1
    s_waitcnt vmcnt(15)
    v_mfma_f32_32x32x16_bf16 v[96:111], a[72:75], v[160:163], v[96:111]
    buffer_load_dwordx4 a[136:139], v1, s[12:15], s18 offen offset:2048 sc1
    s_waitcnt vmcnt(15)
    v_mfma_f32_32x32x16_bf16 v[96:111], a[76:79], v[164:167], v[96:111]
    buffer_load_dwordx4 a[140:143], v1, s[12:15], s18 offen offset:3072 sc1
    ds_read_b128 v[16:19], v5 offset:0
    ds_read_b128 v[20:23], v5 offset:128
    ds_read_b128 v[24:27], v5 offset:256
    ds_read_b128 v[28:31], v5 offset:384
    ds_read_b128 v[32:35], v5 offset:512
    ds_read_b128 v[36:39], v5 offset:640
    s_mov_b32 s41, 10485760
    s_waitcnt lgkmcnt(5)
    buffer_store_dwordx4 v[16:19], v13, s[12:15], s41 offen offset:0 sc1
    s_waitcnt lgkmcnt(4)
    buffer_store_dwordx4 v[20:23], v13, s[12:15], s41 offen offset:128 sc1
    s_waitcnt lgkmcnt(3)
    buffer_store_dwordx4 v[24:27], v13, s[12:15], s41 offen offset:256 sc1
    s_waitcnt lgkmcnt(2)
    buffer_store_dwordx4 v[28:31], v13, s[12:15], s41 offen offset:384 sc1
    s_waitcnt lgkmcnt(1)
    buffer_store_dwordx4 v[32:35], v13, s[12:15], s41 offen offset:512 sc1
    s_waitcnt lgkmcnt(0)
    buffer_store_dwordx4 v[36:39], v13, s[12:15], s41 offen offset:640 sc1
    ds_read_b128 v[40:43], v5 offset:25088
    ds_read_b128 v[44:47], v5 offset:25216
    ds_read_b128 v[48:51], v5 offset:25344
    ds_read_b128 v[52:55], v5 offset:25472
    ds_read_b128 v[56:59], v5 offset:25600
    ds_read_b128 v[60:63], v5 offset:25728
    s_mov_b32 s41, 2097152
    s_waitcnt lgkmcnt(5)
    buffer_store_dwordx4 v[40:43], v14, s[12:15], s41 offen sc1
    s_waitcnt lgkmcnt(4)
    buffer_store_dwordx4 v[44:47], v15, s[12:15], s41 offen sc1
    s_waitcnt lgkmcnt(3)
    s_mov_b32 s41, 2105344
    buffer_store_dwordx4 v[48:51], v14, s[12:15], s41 offen sc1
    s_waitcnt lgkmcnt(2)
    buffer_store_dwordx4 v[52:55], v15, s[12:15], s41 offen sc1
    s_waitcnt lgkmcnt(1)
    s_mov_b32 s41, 2113536
    buffer_store_dwordx4 v[56:59], v14, s[12:15], s41 offen sc1
    s_waitcnt lgkmcnt(0)
    buffer_store_dwordx4 v[60:63], v15, s[12:15], s41 offen sc1
    s_waitcnt vmcnt(27)
    v_mfma_f32_32x32x16_bf16 v[96:111], a[80:83], v[168:171], v[96:111]
    s_waitcnt vmcnt(26)
    v_mfma_f32_32x32x16_bf16 v[96:111], a[84:87], v[172:175], v[96:111]
    s_waitcnt vmcnt(25)
    v_mfma_f32_32x32x16_bf16 v[96:111], a[88:91], v[176:179], v[96:111]
    s_waitcnt vmcnt(24)
    v_mfma_f32_32x32x16_bf16 v[96:111], a[92:95], v[180:183], v[96:111]
    s_waitcnt vmcnt(23)
    v_mfma_f32_32x32x16_bf16 v[96:111], a[96:99], v[184:187], v[96:111]
    s_waitcnt vmcnt(22)
    v_mfma_f32_32x32x16_bf16 v[96:111], a[100:103], v[188:191], v[96:111]
    s_waitcnt vmcnt(21)
    v_mfma_f32_32x32x16_bf16 v[96:111], a[104:107], v[192:195], v[96:111]
    s_waitcnt vmcnt(20)
    v_mfma_f32_32x32x16_bf16 v[96:111], a[108:111], v[196:199], v[96:111]
    s_waitcnt vmcnt(19)
    v_mfma_f32_32x32x16_bf16 v[96:111], a[112:115], v[200:203], v[96:111]
    s_waitcnt vmcnt(18)
    v_mfma_f32_32x32x16_bf16 v[96:111], a[116:119], v[204:207], v[96:111]
    s_waitcnt vmcnt(17)
    v_mfma_f32_32x32x16_bf16 v[96:111], a[120:123], v[208:211], v[96:111]
    s_waitcnt vmcnt(16)
    v_mfma_f32_32x32x16_bf16 v[96:111], a[124:127], v[212:215], v[96:111]
    s_waitcnt vmcnt(15)
    v_mfma_f32_32x32x16_bf16 v[96:111], a[128:131], v[216:219], v[96:111]
    s_waitcnt vmcnt(14)
    v_mfma_f32_32x32x16_bf16 v[96:111], a[132:135], v[220:223], v[96:111]
    s_waitcnt vmcnt(13)
    v_mfma_f32_32x32x16_bf16 v[96:111], a[136:139], v[224:227], v[96:111]
    s_waitcnt vmcnt(12)
    v_mfma_f32_32x32x16_bf16 v[96:111], a[140:143], v[228:231], v[96:111]
    v_cvt_pk_bf16_f32 v112, v64, v65
    v_cvt_pk_bf16_f32 v113, v66, v67
    v_cvt_pk_bf16_f32 v114, v68, v69
    v_cvt_pk_bf16_f32 v115, v70, v71
    v_cvt_pk_bf16_f32 v116, v72, v73
    v_cvt_pk_bf16_f32 v117, v74, v75
    v_cvt_pk_bf16_f32 v118, v76, v77
    v_cvt_pk_bf16_f32 v119, v78, v79
    v_cvt_pk_bf16_f32 v120, v80, v81
    v_cvt_pk_bf16_f32 v121, v82, v83
    v_cvt_pk_bf16_f32 v122, v84, v85
    v_cvt_pk_bf16_f32 v123, v86, v87
    v_cvt_pk_bf16_f32 v124, v88, v89
    v_cvt_pk_bf16_f32 v125, v90, v91
    v_cvt_pk_bf16_f32 v126, v92, v93
    v_cvt_pk_bf16_f32 v127, v94, v95
    v_cvt_pk_bf16_f32 v128, v96, v97
    v_cvt_pk_bf16_f32 v129, v98, v99
    v_cvt_pk_bf16_f32 v130, v100, v101
    v_cvt_pk_bf16_f32 v131, v102, v103
    v_cvt_pk_bf16_f32 v132, v104, v105
    v_cvt_pk_bf16_f32 v133, v106, v107
    v_cvt_pk_bf16_f32 v134, v108, v109
    v_cvt_pk_bf16_f32 v135, v110, v111
    ds_write_b128 v3, v[112:115] offset:50176
    ds_write_b128 v3, v[116:119] offset:50208
    ds_write_b128 v3, v[120:123] offset:50240
    ds_write_b128 v3, v[124:127] offset:50272
    ds_write_b128 v3, v[128:131] offset:50304
    ds_write_b128 v3, v[132:135] offset:50336
    s_waitcnt lgkmcnt(0)
    s_barrier
    ds_read_b128 v[136:139], v5 offset:50176
    ds_read_b128 v[140:143], v5 offset:50304
    ds_read_b128 v[144:147], v5 offset:50432
    ds_read_b128 v[148:151], v5 offset:50560
    ds_read_b128 v[152:155], v5 offset:50688
    ds_read_b128 v[156:159], v5 offset:50816
    s_mov_b32 s41, 6291456
    s_waitcnt lgkmcnt(5)
    buffer_store_dwordx4 v[136:139], v14, s[12:15], s41 offen sc1
    s_waitcnt lgkmcnt(4)
    buffer_store_dwordx4 v[140:143], v15, s[12:15], s41 offen sc1
    s_waitcnt lgkmcnt(3)
    s_mov_b32 s41, 6299648
    buffer_store_dwordx4 v[144:147], v14, s[12:15], s41 offen sc1
    s_waitcnt lgkmcnt(2)
    buffer_store_dwordx4 v[148:151], v15, s[12:15], s41 offen sc1
    s_waitcnt lgkmcnt(1)
    s_mov_b32 s41, 6307840
    buffer_store_dwordx4 v[152:155], v14, s[12:15], s41 offen sc1
    s_waitcnt lgkmcnt(0)
    buffer_store_dwordx4 v[156:159], v15, s[12:15], s41 offen sc1
K1_END:
    s_endpgm
K0_FOLD:
    s_load_dwordx4 s[4:7], s[0:1], 8
    s_load_dwordx4 s[8:11], s[0:1], 24
    s_load_dwordx4 s[48:51], s[0:1], 48
    v_lshrrev_b32 v1, 6, v0
    s_nop 0
    v_readfirstlane_b32 s16, v1
    v_and_b32 v1, 63, v0
    s_cmp_ge_u32 s2, 36
    s_cselect_b32 s14, 1, 0
    s_mul_i32 s15, s14, 36
    s_sub_u32 s15, s2, s15
    s_mul_hi_u32 s17, s15, 0x2AAAAAAB
    s_mul_i32 s18, s17, 6
    s_sub_u32 s18, s15, s18
    s_mov_b32 s19, s14
    s_mul_i32 s36, s16, 768
    s_lshl_b32 s37, s17, 6
    s_mul_i32 s37, s37, 2304
    s_mul_i32 s38, s19, 1536
    s_add_u32 s37, s37, s38
    s_lshl_b32 s38, s18, 6
    s_mul_i32 s38, s38, 2304
    s_add_u32 s38, s38, 768
    s_mov_b32 s39, 0x05555556
    s_movk_i32 s40, 2304
    s_mul_i32 s41, s16, 12288
    v_add_u32 v2, s36, v1
    v_mul_hi_u32 v3, v2, s39
    v_mul_u32_u24 v4, 48, v3
    v_sub_u32 v4, v2, v4
    v_xor_b32 v5, v4, v3
    v_and_b32 v5, 15, v5
    v_and_b32 v4, 48, v4
    v_or_b32 v4, v4, v5
    v_mul_lo_u32 v3, v3, s40
    v_lshl_add_u32 v16, v4, 4, v3
    v_add_u32 v2, s36, v1
    v_add_u32 v2, 64, v2
    v_mul_hi_u32 v3, v2, s39
    v_mul_u32_u24 v4, 48, v3
    v_sub_u32 v4, v2, v4
    v_xor_b32 v5, v4, v3
    v_and_b32 v5, 15, v5
    v_and_b32 v4, 48, v4
    v_or_b32 v4, v4, v5
    v_mul_lo_u32 v3, v3, s40
    v_lshl_add_u32 v17, v4, 4, v3
    v_add_u32 v2, s36, v1
    v_add_u32 v2, 128, v2
    v_mul_hi_u32 v3, v2, s39
    v_mul_u32_u24 v4, 48, v3
    v_sub_u32 v4, v2, v4
    v_xor_b32 v5, v4, v3
    v_and_b32 v5, 15, v5
    v_and_b32 v4, 48, v4
    v_or_b32 v4, v4, v5
    v_mul_lo_u32 v3, v3, s40
    v_lshl_add_u32 v18, v4, 4, v3
    v_add_u32 v2, s36, v1
    v_add_u32 v2, 192, v2
    v_mul_hi_u32 v3, v2, s39
    v_mul_u32_u24 v4, 48, v3
    v_sub_u32 v4, v2, v4
    v_xor_b32 v5, v4, v3
    v_and_b32 v5, 15, v5
    v_and_b32 v4, 48, v4
    v_or_b32 v4, v4, v5
    v_mul_lo_u32 v3, v3, s40
    v_lshl_add_u32 v19, v4, 4, v3
    v_add_u32 v2, s36, v1
    v_add_u32 v2, 256, v2
    v_mul_hi_u32 v3, v2, s39
    v_mul_u32_u24 v4, 48, v3
    v_sub_u32 v4, v2, v4
    v_xor_b32 v5, v4, v3
    v_and_b32 v5, 15, v5
    v_and_b32 v4, 48, v4
    v_or_b32 v4, v4, v5
    v_mul_lo_u32 v3, v3, s40
    v_lshl_add_u32 v20, v4, 4, v3
    v_add_u32 v2, s36, v1
    v_add_u32 v2, 320, v2
    v_mul_hi_u32 v3, v2, s39
    v_mul_u32_u24 v4, 48, v3
    v_sub_u32 v4, v2, v4
    v_xor_b32 v5, v4, v3
    v_and_b32 v5, 15, v5
    v_and_b32 v4, 48, v4
    v_or_b32 v4, v4, v5
    v_mul_lo_u32 v3, v3, s40
    v_lshl_add_u32 v21, v4, 4, v3
    v_add_u32 v2, s36, v1
    v_add_u32 v2, 384, v2
    v_mul_hi_u32 v3, v2, s39
    v_mul_u32_u24 v4, 48, v3
    v_sub_u32 v4, v2, v4
    v_xor_b32 v5, v4, v3
    v_and_b32 v5, 15, v5
    v_and_b32 v4, 48, v4
    v_or_b32 v4, v4, v5
    v_mul_lo_u32 v3, v3, s40
    v_lshl_add_u32 v22, v4, 4, v3
    v_add_u32 v2, s36, v1
    v_add_u32 v2, 448, v2
    v_mul_hi_u32 v3, v2, s39
    v_mul_u32_u24 v4, 48, v3
    v_sub_u32 v4, v2, v4
    v_xor_b32 v5, v4, v3
    v_and_b32 v5, 15, v5
    v_and_b32 v4, 48, v4
    v_or_b32 v4, v4, v5
    v_mul_lo_u32 v3, v3, s40
    v_lshl_add_u32 v23, v4, 4, v3
    v_add_u32 v2, s36, v1
    v_add_u32 v2, 512, v2
    v_mul_hi_u32 v3, v2, s39
    v_mul_u32_u24 v4, 48, v3
    v_sub_u32 v4, v2, v4
    v_xor_b32 v5, v4, v3
    v_and_b32 v5, 15, v5
    v_and_b32 v4, 48, v4
    v_or_b32 v4, v4, v5
    v_mul_lo_u32 v3, v3, s40
    v_lshl_add_u32 v24, v4, 4, v3
    v_add_u32 v2, s36, v1
    v_add_u32 v2, 576, v2
    v_mul_hi_u32 v3, v2, s39
    v_mul_u32_u24 v4, 48, v3
    v_sub_u32 v4, v2, v4
    v_xor_b32 v5, v4, v3
    v_and_b32 v5, 15, v5
    v_and_b32 v4, 48, v4
    v_or_b32 v4, v4, v5
    v_mul_lo_u32 v3, v3, s40
    v_lshl_add_u32 v25, v4, 4, v3
    v_add_u32 v2, s36, v1
    v_add_u32 v2, 640, v2
    v_mul_hi_u32 v3, v2, s39
    v_mul_u32_u24 v4, 48, v3
    v_sub_u32 v4, v2, v4
    v_xor_b32 v5, v4, v3
    v_and_b32 v5, 15, v5
    v_and_b32 v4, 48, v4
    v_or_b32 v4, v4, v5
    v_mul_lo_u32 v3, v3, s40
    v_lshl_add_u32 v26, v4, 4, v3
    v_add_u32 v2, s36, v1
    v_add_u32 v2, 704, v2
    v_mul_hi_u32 v3, v2, s39
    v_mul_u32_u24 v4, 48, v3
    v_sub_u32 v4, v2, v4
    v_xor_b32 v5, v4, v3
    v_and_b32 v5, 15, v5
    v_and_b32 v4, 48, v4
    v_or_b32 v4, v4, v5
    v_mul_lo_u32 v3, v3, s40
    v_lshl_add_u32 v27, v4, 4, v3
    v_lshrrev_b32 v28, 3, v1
    v_mul_u32_u24 v28, 768, v28
    v_and_b32 v3, 7, v1
    v_lshl_add_u32 v28, v3, 4, v28
    s_lshl_b32 s43, s18, 7
    s_mul_i32 s44, s16, 73728
    s_add_u32 s43, s43, s44
    s_lshr_b32 s45, s16, 1
    s_and_b32 s46, s16, 1
    v_and_b32 v2, 31, v1
    v_lshrrev_b32 v3, 5, v1
    s_lshl_b32 s47, s45, 5
    v_add_u32 v4, s47, v2
    v_xor_b32 v5, v3, v4
    v_and_b32 v5, 15, v5
    v_mul_u32_u24 v4, 768, v4
    v_xor_b32 v6, 0, v5
    v_lshl_add_u32 v32, v6, 4, v4
    v_xor_b32 v6, 2, v5
    v_lshl_add_u32 v33, v6, 4, v4
    v_xor_b32 v6, 4, v5
    v_lshl_add_u32 v34, v6, 4, v4
    v_xor_b32 v6, 6, v5
    v_lshl_add_u32 v35, v6, 4, v4
    v_xor_b32 v6, 8, v5
    v_lshl_add_u32 v36, v6, 4, v4
    v_xor_b32 v6, 10, v5
    v_lshl_add_u32 v37, v6, 4, v4
    v_xor_b32 v6, 12, v5
    v_lshl_add_u32 v38, v6, 4, v4
    v_xor_b32 v6, 14, v5
    v_lshl_add_u32 v39, v6, 4, v4
    s_lshl_b32 s47, s46, 5
    v_add_u32 v4, s47, v2
    v_xor_b32 v5, v3, v4
    v_and_b32 v5, 15, v5
    v_mul_u32_u24 v4, 768, v4
    v_add_u32 v4, 49152, v4
    v_xor_b32 v6, 0, v5
    v_lshl_add_u32 v40, v6, 4, v4
    v_xor_b32 v6, 2, v5
    v_lshl_add_u32 v41, v6, 4, v4
    v_xor_b32 v6, 4, v5
    v_lshl_add_u32 v42, v6, 4, v4
    v_xor_b32 v6, 6, v5
    v_lshl_add_u32 v43, v6, 4, v4
    v_xor_b32 v6, 8, v5
    v_lshl_add_u32 v44, v6, 4, v4
    v_xor_b32 v6, 10, v5
    v_lshl_add_u32 v45, v6, 4, v4
    v_xor_b32 v6, 12, v5
    v_lshl_add_u32 v46, v6, 4, v4
    v_xor_b32 v6, 14, v5
    v_lshl_add_u32 v47, v6, 4, v4
    v_and_b32 v6, 15, v1
    v_lshrrev_b32 v7, 2, v6
    v_lshl_add_u32 v7, v3, 3, v7
    v_lshlrev_b32 v7, 7, v7
    v_and_b32 v8, 3, v6
    v_lshl_add_u32 v7, v8, 3, v7
    v_bfe_u32 v8, v1, 4, 1
    v_lshl_add_u32 v7, v8, 5, v7
    s_lshl_b32 s47, s46, 6
    s_add_u32 s47, s47, 49152
    v_add_u32 v7, s47, v7
    v_lshlrev_b32 v29, 4, v1
    s_lshl_b32 s52, s18, 1
    s_add_u32 s52, s52, s46
    s_mul_i32 s52, s52, 24
    s_lshl_b32 s53, s17, 1
    s_add_u32 s53, s53, s45
    s_lshl_b32 s53, s53, 1
    s_add_u32 s52, s52, s53
    s_lshl_b32 s52, s52, 10
    s_waitcnt lgkmcnt(0)
    s_mov_b32 s32, s50
    s_and_b32 s33, s51, 0xffff
    s_mov_b32 s34, 268435456
    s_mov_b32 s35, 0x00020000
    s_mov_b32 s56, s48
    s_and_b32 s57, s49, 0xffff
    s_mov_b32 s58, 256
    s_mov_b32 s59, 0x00020000
    s_mov_b32 s20, s4
    s_mov_b32 s21, s5
    s_mov_b32 s22, s6
    s_mov_b32 s23, s7
K0_PASS:
    s_mov_b32 s24, s20
    s_and_b32 s25, s21, 0xffff
    s_mov_b32 s26, 884736
    s_mov_b32 s27, 0x00020000
    s_mov_b32 s28, s22
    s_and_b32 s29, s23, 0xffff
    s_mov_b32 s30, 294912
    s_mov_b32 s31, 0x00020000
    s_add_u32 m0, s41, 0
    s_nop 0
    buffer_load_dwordx4 v16, s[24:27], s37 offen lds
    s_add_u32 m0, s41, 1024
    s_nop 0
    buffer_load_dwordx4 v17, s[24:27], s37 offen lds
    s_add_u32 m0, s41, 2048
    s_nop 0
    buffer_load_dwordx4 v18, s[24:27], s37 offen lds
    s_add_u32 m0, s41, 3072
    s_nop 0
    buffer_load_dwordx4 v19, s[24:27], s37 offen lds
    s_add_u32 m0, s41, 4096
    s_nop 0
    buffer_load_dwordx4 v20, s[24:27], s37 offen lds
    s_add_u32 m0, s41, 5120
    s_nop 0
    buffer_load_dwordx4 v21, s[24:27], s37 offen lds
    s_add_u32 m0, s41, 6144
    s_nop 0
    buffer_load_dwordx4 v22, s[24:27], s37 offen lds
    s_add_u32 m0, s41, 7168
    s_nop 0
    buffer_load_dwordx4 v23, s[24:27], s37 offen lds
    s_add_u32 m0, s41, 8192
    s_nop 0
    buffer_load_dwordx4 v24, s[24:27], s37 offen lds
    s_add_u32 m0, s41, 9216
    s_nop 0
    buffer_load_dwordx4 v25, s[24:27], s37 offen lds
    s_add_u32 m0, s41, 10240
    s_nop 0
    buffer_load_dwordx4 v26, s[24:27], s37 offen lds
    s_add_u32 m0, s41, 11264
    s_nop 0
    buffer_load_dwordx4 v27, s[24:27], s37 offen lds
    s_cmp_eq_u32 s19, 1
    s_cbranch_scc1 K0_VO
    s_add_u32 m0, s41, 49152
    s_nop 0
    buffer_load_dwordx4 v16, s[24:27], s38 offen lds
    s_add_u32 m0, s41, 50176
    s_nop 0
    buffer_load_dwordx4 v17, s[24:27], s38 offen lds
    s_add_u32 m0, s41, 51200
    s_nop 0
    buffer_load_dwordx4 v18, s[24:27], s38 offen lds
    s_add_u32 m0, s41, 52224
    s_nop 0
    buffer_load_dwordx4 v19, s[24:27], s38 offen lds
    s_add_u32 m0, s41, 53248
    s_nop 0
    buffer_load_dwordx4 v20, s[24:27], s38 offen lds
    s_add_u32 m0, s41, 54272
    s_nop 0
    buffer_load_dwordx4 v21, s[24:27], s38 offen lds
    s_add_u32 m0, s41, 55296
    s_nop 0
    buffer_load_dwordx4 v22, s[24:27], s38 offen lds
    s_add_u32 m0, s41, 56320
    s_nop 0
    buffer_load_dwordx4 v23, s[24:27], s38 offen lds
    s_add_u32 m0, s41, 57344
    s_nop 0
    buffer_load_dwordx4 v24, s[24:27], s38 offen lds
    s_add_u32 m0, s41, 58368
    s_nop 0
    buffer_load_dwordx4 v25, s[24:27], s38 offen lds
    s_add_u32 m0, s41, 59392
    s_nop 0
    buffer_load_dwordx4 v26, s[24:27], s38 offen lds
    s_add_u32 m0, s41, 60416
    s_nop 0
    buffer_load_dwordx4 v27, s[24:27], s38 offen lds
    s_branch K0_ST
K0_VO:
    s_add_u32 m0, s41, 49152
    s_add_u32 s44, s43, 0
    buffer_load_dwordx4 v28, s[28:31], s44 offen lds
    s_add_u32 m0, s41, 50176
    s_add_u32 s44, s43, 6144
    buffer_load_dwordx4 v28, s[28:31], s44 offen lds
    s_add_u32 m0, s41, 51200
    s_add_u32 s44, s43, 12288
    buffer_load_dwordx4 v28, s[28:31], s44 offen lds
    s_add_u32 m0, s41, 52224
    s_add_u32 s44, s43, 18432
    buffer_load_dwordx4 v28, s[28:31], s44 offen lds
    s_add_u32 m0, s41, 53248
    s_add_u32 s44, s43, 24576
    buffer_load_dwordx4 v28, s[28:31], s44 offen lds
    s_add_u32 m0, s41, 54272
    s_add_u32 s44, s43, 30720
    buffer_load_dwordx4 v28, s[28:31], s44 offen lds
    s_add_u32 m0, s41, 55296
    s_add_u32 s44, s43, 36864
    buffer_load_dwordx4 v28, s[28:31], s44 offen lds
    s_add_u32 m0, s41, 56320
    s_add_u32 s44, s43, 43008
    buffer_load_dwordx4 v28, s[28:31], s44 offen lds
    s_add_u32 m0, s41, 57344
    s_add_u32 s44, s43, 49152
    buffer_load_dwordx4 v28, s[28:31], s44 offen lds
    s_add_u32 m0, s41, 58368
    s_add_u32 s44, s43, 55296
    buffer_load_dwordx4 v28, s[28:31], s44 offen lds
    s_add_u32 m0, s41, 59392
    s_add_u32 s44, s43, 61440
    buffer_load_dwordx4 v28, s[28:31], s44 offen lds
    s_add_u32 m0, s41, 60416
    s_add_u32 s44, s43, 67584
    buffer_load_dwordx4 v28, s[28:31], s44 offen lds
K0_ST:
    s_waitcnt vmcnt(0)
    s_barrier
    ds_read_b128 v[48:51], v32 offset:0
    ds_read_b128 v[52:55], v33 offset:0
    ds_read_b128 v[56:59], v34 offset:0
    ds_read_b128 v[60:63], v35 offset:0
    ds_read_b128 v[64:67], v36 offset:0
    ds_read_b128 v[68:71], v37 offset:0
    ds_read_b128 v[72:75], v38 offset:0
    ds_read_b128 v[76:79], v39 offset:0
    ds_read_b128 v[80:83], v32 offset:256
    ds_read_b128 v[84:87], v33 offset:256
    ds_read_b128 v[88:91], v34 offset:256
    ds_read_b128 v[92:95], v35 offset:256
    ds_read_b128 v[96:99], v36 offset:256
    ds_read_b128 v[100:103], v37 offset:256
    ds_read_b128 v[104:107], v38 offset:256
    ds_read_b128 v[108:111], v39 offset:256
    ds_read_b128 v[112:115], v32 offset:512
    ds_read_b128 v[116:119], v33 offset:512
    ds_read_b128 v[120:123], v34 offset:512
    ds_read_b128 v[124:127], v35 offset:512
    ds_read_b128 v[128:131], v36 offset:512
    ds_read_b128 v[132:135], v37 offset:512
    ds_read_b128 v[136:139], v38 offset:512
    ds_read_b128 v[140:143], v39 offset:512
    s_cmp_eq_u32 s19, 1
    s_cbranch_scc1 K0_VO2
    ds_read_b128 v[144:147], v40 offset:0
    ds_read_b128 v[148:151], v41 offset:0
    ds_read_b128 v[152:155], v42 offset:0
    ds_read_b128 v[156:159], v43 offset:0
    ds_read_b128 v[160:163], v44 offset:0
    ds_read_b128 v[164:167], v45 offset:0
    ds_read_b128 v[168:171], v46 offset:0
    ds_read_b128 v[172:175], v47 offset:0
    ds_read_b128 v[176:179], v40 offset:256
    ds_read_b128 v[180:183], v41 offset:256
    ds_read_b128 v[184:187], v42 offset:256
    ds_read_b128 v[188:191], v43 offset:256
    ds_read_b128 v[192:195], v44 offset:256
    ds_read_b128 v[196:199], v45 offset:256
    ds_read_b128 v[200:203], v46 offset:256
    ds_read_b128 v[204:207], v47 offset:256
    ds_read_b128 v[208:211], v40 offset:512
    ds_read_b128 v[212:215], v41 offset:512
    ds_read_b128 v[216:219], v42 offset:512
    ds_read_b128 v[220:223], v43 offset:512
    ds_read_b128 v[224:227], v44 offset:512
    ds_read_b128 v[228:231], v45 offset:512
    ds_read_b128 v[232:235], v46 offset:512
    ds_read_b128 v[236:239], v47 offset:512
    s_mov_b32 s40, 0x3d96c740
    s_branch K0_MM
K0_VO2:
    ds_read_b64_tr_b16 v[144:145], v7 offset:0
    ds_read_b64_tr_b16 v[146:147], v7 offset:512
    ds_read_b64_tr_b16 v[148:149], v7 offset:2048
    ds_read_b64_tr_b16 v[150:151], v7 offset:2560
    ds_read_b64_tr_b16 v[152:153], v7 offset:4096
    ds_read_b64_tr_b16 v[154:155], v7 offset:4608
    ds_read_b64_tr_b16 v[156:157], v7 offset:6144
    ds_read_b64_tr_b16 v[158:159], v7 offset:6656
    ds_read_b64_tr_b16 v[160:161], v7 offset:8192
    ds_read_b64_tr_b16 v[162:163], v7 offset:8704
    ds_read_b64_tr_b16 v[164:165], v7 offset:10240
    ds_read_b64_tr_b16 v[166:167], v7 offset:10752
    ds_read_b64_tr_b16 v[168:169], v7 offset:12288
    ds_read_b64_tr_b16 v[170:171], v7 offset:12800
    ds_read_b64_tr_b16 v[172:173], v7 offset:14336
    ds_read_b64_tr_b16 v[174:175], v7 offset:14848
    ds_read_b64_tr_b16 v[176:177], v7 offset:16384
    ds_read_b64_tr_b16 v[178:179], v7 offset:16896
    ds_read_b64_tr_b16 v[180:181], v7 offset:18432
    ds_read_b64_tr_b16 v[182:183], v7 offset:18944
    ds_read_b64_tr_b16 v[184:185], v7 offset:20480
    ds_read_b64_tr_b16 v[186:187], v7 offset:20992
    ds_read_b64_tr_b16 v[188:189], v7 offset:22528
    ds_read_b64_tr_b16 v[190:191], v7 offset:23040
    ds_read_b64_tr_b16 v[192:193], v7 offset:24576
    ds_read_b64_tr_b16 v[194:195], v7 offset:25088
    ds_read_b64_tr_b16 v[196:197], v7 offset:26624
    ds_read_b64_tr_b16 v[198:199], v7 offset:27136
    ds_read_b64_tr_b16 v[200:201], v7 offset:28672
    ds_read_b64_tr_b16 v[202:203], v7 offset:29184
    ds_read_b64_tr_b16 v[204:205], v7 offset:30720
    ds_read_b64_tr_b16 v[206:207], v7 offset:31232
    ds_read_b64_tr_b16 v[208:209], v7 offset:32768
    ds_read_b64_tr_b16 v[210:211], v7 offset:33280
    ds_read_b64_tr_b16 v[212:213], v7 offset:34816
    ds_read_b64_tr_b16 v[214:215], v7 offset:35328
    ds_read_b64_tr_b16 v[216:217], v7 offset:36864
    ds_read_b64_tr_b16 v[218:219], v7 offset:37376
    ds_read_b64_tr_b16 v[220:221], v7 offset:38912
    ds_read_b64_tr_b16 v[222:223], v7 offset:39424
    ds_read_b64_tr_b16 v[224:225], v7 offset:40960
    ds_read_b64_tr_b16 v[226:227], v7 offset:41472
    ds_read_b64_tr_b16 v[228:229], v7 offset:43008
    ds_read_b64_tr_b16 v[230:231], v7 offset:43520
    ds_read_b64_tr_b16 v[232:233], v7 offset:45056
    ds_read_b64_tr_b16 v[234:235], v7 offset:45568
    ds_read_b64_tr_b16 v[236:237], v7 offset:47104
    ds_read_b64_tr_b16 v[238:239], v7 offset:47616
    s_mov_b32 s40, 1.0
K0_MM:
    s_waitcnt lgkmcnt(0)
    v_mfma_f32_32x32x16_bf16 v[240:255], v[48:51], v[144:147], 0
    v_mfma_f32_32x32x16_bf16 v[240:255], v[52:55], v[148:151], v[240:255]
    v_mfma_f32_32x32x16_bf16 v[240:255], v[56:59], v[152:155], v[240:255]
    v_mfma_f32_32x32x16_bf16 v[240:255], v[60:63], v[156:159], v[240:255]
    v_mfma_f32_32x32x16_bf16 v[240:255], v[64:67], v[160:163], v[240:255]
    v_mfma_f32_32x32x16_bf16 v[240:255], v[68:71], v[164:167], v[240:255]
    v_mfma_f32_32x32x16_bf16 v[240:255], v[72:75], v[168:171], v[240:255]
    v_mfma_f32_32x32x16_bf16 v[240:255], v[76:79], v[172:175], v[240:255]
    v_mfma_f32_32x32x16_bf16 v[240:255], v[80:83], v[176:179], v[240:255]
    v_mfma_f32_32x32x16_bf16 v[240:255], v[84:87], v[180:183], v[240:255]
    v_mfma_f32_32x32x16_bf16 v[240:255], v[88:91], v[184:187], v[240:255]
    v_mfma_f32_32x32x16_bf16 v[240:255], v[92:95], v[188:191], v[240:255]
    v_mfma_f32_32x32x16_bf16 v[240:255], v[96:99], v[192:195], v[240:255]
    v_mfma_f32_32x32x16_bf16 v[240:255], v[100:103], v[196:199], v[240:255]
    v_mfma_f32_32x32x16_bf16 v[240:255], v[104:107], v[200:203], v[240:255]
    v_mfma_f32_32x32x16_bf16 v[240:255], v[108:111], v[204:207], v[240:255]
    v_mfma_f32_32x32x16_bf16 v[240:255], v[112:115], v[208:211], v[240:255]
    v_mfma_f32_32x32x16_bf16 v[240:255], v[116:119], v[212:215], v[240:255]
    v_mfma_f32_32x32x16_bf16 v[240:255], v[120:123], v[216:219], v[240:255]
    v_mfma_f32_32x32x16_bf16 v[240:255], v[124:127], v[220:223], v[240:255]
    v_mfma_f32_32x32x16_bf16 v[240:255], v[128:131], v[224:227], v[240:255]
    v_mfma_f32_32x32x16_bf16 v[240:255], v[132:135], v[228:231], v[240:255]
    v_mfma_f32_32x32x16_bf16 v[240:255], v[136:139], v[232:235], v[240:255]
    v_mfma_f32_32x32x16_bf16 v[240:255], v[140:143], v[236:239], v[240:255]
    s_nop 11
    v_mul_f32 v240, s40, v240
    v_mul_f32 v241, s40, v241
    v_mul_f32 v242, s40, v242
    v_mul_f32 v243, s40, v243
    v_mul_f32 v244, s40, v244
    v_mul_f32 v245, s40, v245
    v_mul_f32 v246, s40, v246
    v_mul_f32 v247, s40, v247
    v_mul_f32 v248, s40, v248
    v_mul_f32 v249, s40, v249
    v_mul_f32 v250, s40, v250
    v_mul_f32 v251, s40, v251
    v_mul_f32 v252, s40, v252
    v_mul_f32 v253, s40, v253
    v_mul_f32 v254, s40, v254
    v_mul_f32 v255, s40, v255
    v_cvt_pk_bf16_f32 v8, v240, v241
    v_cvt_pk_bf16_f32 v9, v242, v243
    v_cvt_pk_bf16_f32 v10, v244, v245
    v_cvt_pk_bf16_f32 v11, v246, v247
    v_cvt_pk_bf16_f32 v12, v248, v249
    v_cvt_pk_bf16_f32 v13, v250, v251
    v_cvt_pk_bf16_f32 v14, v252, v253
    v_cvt_pk_bf16_f32 v15, v254, v255
    s_mul_i32 s36, s14, 294912
    s_add_u32 s36, s36, s52
    buffer_store_dwordx4 v[8:11], v29, s[32:35], s36 offen sc1
    buffer_store_dwordx4 v[12:15], v29, s[32:35], s36 offen offset:1024 sc1
    s_waitcnt vmcnt(0)
    s_barrier
    s_cmp_lg_u32 s16, 0
    s_cbranch_scc1 K0_NOPUB
    s_lshl_b32 s36, s14, 2
    s_add_u32 s36, s36, 240
    v_mov_b32 v2, 1
    v_mov_b32 v3, 0
    s_mov_b64 exec, 1
    buffer_atomic_add v2, v3, s[56:59], s36 offen sc0 sc1
    s_waitcnt vmcnt(0)
    v_readfirstlane_b32 s47, v2
    s_cmp_lg_u32 s47, 35
    s_cbranch_scc1 K0_NOTLAST
    s_sub_u32 s36, s36, 128
    v_mov_b32 v2, 36
    buffer_store_dword v2, v3, s[56:59], s36 offen sc1
K0_NOTLAST:
    s_mov_b64 exec, -1
K0_NOPUB:
    s_cmp_ge_u32 s14, 2
    s_cbranch_scc1 K0_ZERO
    s_add_u32 s14, s14, 2
    s_mov_b32 s20, s8
    s_mov_b32 s21, s9
    s_mov_b32 s22, s10
    s_mov_b32 s23, s11
    s_nop 15
    s_branch K0_PASS
K0_ZERO:
    s_cmp_ge_u32 s2, 21
    s_cbranch_scc1 K1_END
    s_mul_hi_u32 s36, s2, 0x55555556
    s_mul_i32 s37, s36, 3
    s_sub_u32 s37, s2, s37
    s_lshl_b32 s37, s37, 13
    s_mul_i32 s38, s36, 565248
    s_add_u32 s38, s38, s37
    s_add_u32 s38, s38, 2644224
    v_lshlrev_b32 v2, 4, v0
    s_movk_i32 s39, 1792
    v_cmp_gt_u32 vcc, s39, v2
    v_mov_b32 v3, 2130706432
    s_nop 0
    v_cndmask_b32 v2, v3, v2, vcc
    v_mov_b32 v4, 0
    v_mov_b32 v5, 0
    v_mov_b32 v6, 0
    v_mov_b32 v7, 0
    buffer_store_dwordx4 v[4:7], v2, s[32:35], s38 offen sc1
    s_endpgm
.globl spatial_kernel
.p2align 8
.type spatial_kernel,@function
spatial_kernel:
    s_cmp_ge_u32 s2, 184
    s_cbranch_scc1 K2_END
    s_and_b32 s17, s2, 7
    s_cmp_eq_u32 s17, 7
    s_cbranch_scc1 K2_END
    s_lshr_b32 s18, s2, 3
    s_load_dwordx2 s[4:5], s[0:1], 40
    s_load_dwordx2 s[6:7], s[0:1], 56
    v_lshrrev_b32 v1, 6, v0
    s_nop 0
    v_readfirstlane_b32 s16, v1
    v_and_b32 v8, 63, v0
    v_lshlrev_b32 v1, 4, v8
    v_and_b32 v9, 31, v8
    v_lshrrev_b32 v10, 5, v8
    s_mul_i32 s19, s16, 40960
    s_mul_i32 s20, s17, 565248
    s_mul_i32 s21, s18, 24576
    s_add_u32 s21, s21, s20
    s_mul_i32 s22, s16, 24576
    s_add_u32 s22, s22, s20
    s_add_u32 s22, s22, 2097152
    s_mul_i32 s28, s16, 73728
    s_waitcnt lgkmcnt(0)
    s_mov_b32 s8, s4
    s_and_b32 s9, s5, 0xffff
    s_mov_b32 s10, 3919104
    s_mov_b32 s11, 0x00020000
    s_mov_b32 s12, s6
    s_and_b32 s13, s7, 0xffff
    s_mov_b32 s14, 268435456
    s_mov_b32 s15, 0x00020000
    s_add_u32 s23, s21, 6291456
    s_mul_i32 s30, s16, 6144
    s_add_u32 s31, s30, 0
    s_cmp_ge_u32 s31, 16384
    s_cselect_b32 s35, 24576, 0
    s_add_u32 s35, s35, 16384
    s_add_u32 m0, s31, s35
    s_add_u32 s32, s31, s23
    buffer_load_dwordx4 v1, s[12:15], s32 offen lds
    s_add_u32 s31, s30, 1024
    s_cmp_ge_u32 s31, 16384
    s_cselect_b32 s35, 24576, 0
    s_add_u32 s35, s35, 16384
    s_add_u32 m0, s31, s35
    s_add_u32 s32, s31, s23
    buffer_load_dwordx4 v1, s[12:15], s32 offen lds
    s_add_u32 s31, s30, 2048
    s_cmp_ge_u32 s31, 16384
    s_cselect_b32 s35, 24576, 0
    s_add_u32 s35, s35, 16384
    s_add_u32 m0, s31, s35
    s_add_u32 s32, s31, s23
    buffer_load_dwordx4 v1, s[12:15], s32 offen lds
    s_add_u32 s31, s30, 3072
    s_cmp_ge_u32 s31, 16384
    s_cselect_b32 s35, 24576, 0
    s_add_u32 s35, s35, 16384
    s_add_u32 m0, s31, s35
    s_add_u32 s32, s31, s23
    buffer_load_dwordx4 v1, s[12:15], s32 offen lds
    s_add_u32 s31, s30, 4096
    s_cmp_ge_u32 s31, 16384
    s_cselect_b32 s35, 24576, 0
    s_add_u32 s35, s35, 16384
    s_add_u32 m0, s31, s35
    s_add_u32 s32, s31, s23
    buffer_load_dwordx4 v1, s[12:15], s32 offen lds
    s_add_u32 s31, s30, 5120
    s_cmp_ge_u32 s31, 16384
    s_cselect_b32 s35, 24576, 0
    s_add_u32 s35, s35, 16384
    s_add_u32 m0, s31, s35
    s_add_u32 s32, s31, s23
    buffer_load_dwordx4 v1, s[12:15], s32 offen lds
    s_add_u32 m0, s19, 0
    s_add_u32 s27, s22, 0
    buffer_load_dwordx4 v1, s[12:15], s27 offen offset:0 lds
    buffer_load_dwordx4 v1, s[12:15], s27 offen offset:1024 lds
    buffer_load_dwordx4 v1, s[12:15], s27 offen offset:2048 lds
    buffer_load_dwordx4 v1, s[12:15], s27 offen offset:3072 lds
    s_add_u32 m0, s19, 4096
    s_add_u32 s27, s22, 4096
    buffer_load_dwordx4 v1, s[12:15], s27 offen offset:0 lds
    buffer_load_dwordx4 v1, s[12:15], s27 offen offset:1024 lds
    buffer_load_dwordx4 v1, s[12:15], s27 offen offset:2048 lds
    buffer_load_dwordx4 v1, s[12:15], s27 offen offset:3072 lds
    v_and_b32 v11, 3, v9
    v_lshlrev_b32 v11, 2, v11
    v_bfe_u32 v12, v9, 2, 2
    v_or_b32 v11, v11, v12
    v_xor_b32 v11, v11, v10
    v_lshlrev_b32 v12, 8, v9
    v_xor_b32 v13, 0, v11
    v_lshl_add_u32 v232, v13, 4, v12
    v_xor_b32 v13, 2, v11
    v_lshl_add_u32 v233, v13, 4, v12
    v_xor_b32 v13, 4, v11
    v_lshl_add_u32 v234, v13, 4, v12
    v_xor_b32 v13, 6, v11
    v_lshl_add_u32 v235, v13, 4, v12
    v_xor_b32 v13, 8, v11
    s_add_u32 m0, s19, 8192
    s_add_u32 s27, s22, 8192
    buffer_load_dwordx4 v1, s[12:15], s27 offen offset:0 lds
    v_lshl_add_u32 v236, v13, 4, v12
    v_xor_b32 v13, 10, v11
    v_lshl_add_u32 v237, v13, 4, v12
    v_xor_b32 v13, 12, v11
    v_lshl_add_u32 v238, v13, 4, v12
    v_xor_b32 v13, 14, v11
    v_lshl_add_u32 v239, v13, 4, v12
    v_and_b32 v11, 15, v8
    v_lshrrev_b32 v12, 2, v11
    v_lshl_add_u32 v13, v10, 2, v12
    buffer_load_dwordx4 v1, s[12:15], s27 offen offset:1024 lds
    v_lshlrev_b32 v13, 8, v13
    v_add_u32 v13, s19, v13
    v_bfe_u32 v14, v11, 1, 1
    v_lshl_add_u32 v13, v14, 3, v13
    v_bfe_u32 v14, v8, 4, 1
    v_and_b32 v15, 1, v11
    v_lshl_add_u32 v14, v14, 1, v15
    v_lshl_add_u32 v12, v12, 2, v10
    v_xor_b32 v14, v14, v12
    s_add_u32 s26, s16, 0
    buffer_load_dwordx4 v1, s[12:15], s27 offen offset:2048 lds
    s_and_b32 s26, s26, 3
    s_lshl_b32 s26, s26, 2
    v_xor_b32 v15, 0, v14
    v_xor_b32 v15, s26, v15
    v_lshl_add_u32 v240, v15, 4, v13
    v_xor_b32 v15, 2, v14
    v_xor_b32 v15, s26, v15
    v_lshl_add_u32 v241, v15, 4, v13
    v_add_u32 v241, 2048, v241
    s_add_u32 s26, s16, 1
    buffer_load_dwordx4 v1, s[12:15], s27 offen offset:3072 lds
    s_and_b32 s26, s26, 3
    s_lshl_b32 s26, s26, 2
    v_xor_b32 v15, 0, v14
    v_xor_b32 v15, s26, v15
    v_lshl_add_u32 v242, v15, 4, v13
    v_xor_b32 v15, 2, v14
    v_xor_b32 v15, s26, v15
    v_lshl_add_u32 v243, v15, 4, v13
    v_add_u32 v243, 2048, v243
    s_add_u32 s26, s16, 2
    s_add_u32 m0, s19, 12288
    s_add_u32 s27, s22, 12288
    buffer_load_dwordx4 v1, s[12:15], s27 offen offset:0 lds
    s_and_b32 s26, s26, 3
    s_lshl_b32 s26, s26, 2
    v_xor_b32 v15, 0, v14
    v_xor_b32 v15, s26, v15
    v_lshl_add_u32 v244, v15, 4, v13
    v_xor_b32 v15, 2, v14
    v_xor_b32 v15, s26, v15
    v_lshl_add_u32 v245, v15, 4, v13
    v_add_u32 v245, 2048, v245
    s_add_u32 s26, s16, 3
    buffer_load_dwordx4 v1, s[12:15], s27 offen offset:1024 lds
    s_and_b32 s26, s26, 3
    s_lshl_b32 s26, s26, 2
    v_xor_b32 v15, 0, v14
    v_xor_b32 v15, s26, v15
    v_lshl_add_u32 v246, v15, 4, v13
    v_xor_b32 v15, 2, v14
    v_xor_b32 v15, s26, v15
    v_lshl_add_u32 v247, v15, 4, v13
    v_add_u32 v247, 2048, v247
    s_mov_b32 s24, 0x41c00000
    buffer_load_dwordx4 v1, s[12:15], s27 offen offset:2048 lds
    s_mov_b32 s25, 0xff800000
    v_mov_b32 v7, 0
    buffer_load_dwordx4 v1, s[12:15], s27 offen offset:3072 lds
    s_add_u32 m0, s19, 32768
    s_add_u32 s27, s22, 16384
    buffer_load_dwordx4 v1, s[12:15], s27 offen offset:0 lds
    buffer_load_dwordx4 v1, s[12:15], s27 offen offset:1024 lds
    buffer_load_dwordx4 v1, s[12:15], s27 offen offset:2048 lds
    s_waitcnt vmcnt(19)
    s_barrier
    ds_read_b128 a[0:3], v232 offset:16384
    ds_read_b128 a[4:7], v233 offset:16384
    ds_read_b128 a[8:11], v234 offset:16384
    ds_read_b128 a[12:15], v235 offset:16384
    ds_read_b128 a[16:19], v236 offset:16384
    ds_read_b128 a[20:23], v237 offset:16384
    ds_read_b128 a[24:27], v238 offset:16384
    ds_read_b128 a[28:31], v239 offset:16384
    buffer_load_dwordx4 v1, s[12:15], s27 offen offset:3072 lds
    ds_read_b128 a[32:35], v232 offset:24576
    ds_read_b128 a[36:39], v233 offset:24576
    ds_read_b128 a[40:43], v234 offset:24576
    ds_read_b128 a[44:47], v235 offset:24576
    ds_read_b128 a[48:51], v236 offset:24576
    ds_read_b128 a[52:55], v237 offset:24576
    ds_read_b128 a[56:59], v238 offset:24576
    ds_read_b128 a[60:63], v239 offset:24576
    ds_read_b128 a[64:67], v232 offset:57344
    ds_read_b128 a[68:71], v233 offset:57344
    s_add_u32 m0, s19, 36864
    s_add_u32 s27, s22, 20480
    buffer_load_dwordx4 v1, s[12:15], s27 offen offset:0 lds
    ds_read_b128 a[72:75], v234 offset:57344
    ds_read_b128 a[76:79], v235 offset:57344
    ds_read_b128 a[80:83], v236 offset:57344
    ds_read_b128 a[84:87], v237 offset:57344
    ds_read_b128 a[88:91], v238 offset:57344
    ds_read_b128 a[92:95], v239 offset:57344
    v_add_u32 v232, s19, v232
    v_add_u32 v233, s19, v233
    v_add_u32 v234, s19, v234
    v_add_u32 v235, s19, v235
    buffer_load_dwordx4 v1, s[12:15], s27 offen offset:1024 lds
    v_add_u32 v236, s19, v236
    v_add_u32 v237, s19, v237
    v_add_u32 v238, s19, v238
    v_add_u32 v239, s19, v239
    buffer_load_dwordx4 v1, s[12:15], s27 offen offset:2048 lds
    buffer_load_dwordx4 v1, s[12:15], s27 offen offset:3072 lds
    s_waitcnt lgkmcnt(0)
    s_barrier
    s_waitcnt vmcnt(8)
    ds_read_b128 a[96:99], v232 offset:0
    ds_read_b128 a[100:103], v233 offset:0
    ds_read_b128 a[104:107], v234 offset:0
    ds_read_b128 a[108:111], v235 offset:0
    ds_read_b128 a[112:115], v236 offset:0
    ds_read_b128 a[116:119], v237 offset:0
    ds_read_b128 a[120:123], v238 offset:0
    s_add_u32 m0, s19, 16384
    s_add_u32 s27, s22, 98304
    buffer_load_dwordx4 v1, s[12:15], s27 offen offset:0 lds
    s_waitcnt lgkmcnt(5)
    v_mfma_f32_32x32x16_bf16 v[16:31], a[96:99], a[0:3], 0
    ds_read_b128 a[124:127], v239 offset:0
    v_mfma_f32_32x32x16_bf16 v[16:31], a[100:103], a[4:7], v[16:31]
    buffer_load_dwordx4 v1, s[12:15], s27 offen offset:1024 lds
    ds_read_b128 a[96:99], v232 offset:8192
    s_waitcnt lgkmcnt(5)
    v_mfma_f32_32x32x16_bf16 v[16:31], a[104:107], a[8:11], v[16:31]
    ds_read_b128 a[100:103], v233 offset:8192
    v_mfma_f32_32x32x16_bf16 v[16:31], a[108:111], a[12:15], v[16:31]
    buffer_load_dwordx4 v1, s[12:15], s27 offen offset:2048 lds
    ds_read_b128 a[104:107], v234 offset:8192
    s_waitcnt lgkmcnt(5)
    v_mfma_f32_32x32x16_bf16 v[16:31], a[112:115], a[16:19], v[16:31]
    ds_read_b128 a[108:111], v235 offset:8192
    v_mfma_f32_32x32x16_bf16 v[16:31], a[116:119], a[20:23], v[16:31]
    buffer_load_dwordx4 v1, s[12:15], s27 offen offset:3072 lds
    ds_read_b128 a[112:115], v236 offset:8192
    s_waitcnt lgkmcnt(5)
    v_mfma_f32_32x32x16_bf16 v[16:31], a[120:123], a[24:27], v[16:31]
    ds_read_b128 a[116:119], v237 offset:8192
    v_mfma_f32_32x32x16_bf16 v[16:31], a[124:127], a[28:31], v[16:31]
    s_add_u32 m0, s19, 20480
    s_add_u32 s27, s22, 102400
    buffer_load_dwordx4 v1, s[12:15], s27 offen offset:0 lds
    ds_read_b128 a[120:123], v238 offset:8192
    s_waitcnt lgkmcnt(5)
    v_mfma_f32_32x32x16_bf16 v[16:31], a[96:99], a[32:35], v[16:31]
    ds_read_b128 a[124:127], v239 offset:8192
    v_mfma_f32_32x32x16_bf16 v[16:31], a[100:103], a[36:39], v[16:31]
    buffer_load_dwordx4 v1, s[12:15], s27 offen offset:1024 lds
    s_waitcnt vmcnt(6)
    ds_read_b128 a[96:99], v232 offset:32768
    s_waitcnt lgkmcnt(5)
    v_mfma_f32_32x32x16_bf16 v[16:31], a[104:107], a[40:43], v[16:31]
    ds_read_b128 a[100:103], v233 offset:32768
    v_mfma_f32_32x32x16_bf16 v[16:31], a[108:111], a[44:47], v[16:31]
    buffer_load_dwordx4 v1, s[12:15], s27 offen offset:2048 lds
    ds_read_b128 a[104:107], v234 offset:32768
    s_waitcnt lgkmcnt(5)
    v_mfma_f32_32x32x16_bf16 v[16:31], a[112:115], a[48:51], v[16:31]
    ds_read_b128 a[108:111], v235 offset:32768
    v_mfma_f32_32x32x16_bf16 v[16:31], a[116:119], a[52:55], v[16:31]
    buffer_load_dwordx4 v1, s[12:15], s27 offen offset:3072 lds
    ds_read_b128 a[112:115], v236 offset:32768
    s_waitcnt lgkmcnt(5)
    v_mfma_f32_32x32x16_bf16 v[16:31], a[120:123], a[56:59], v[16:31]
    ds_read_b128 a[116:119], v237 offset:32768
    v_mfma_f32_32x32x16_bf16 v[16:31], a[124:127], a[60:63], v[16:31]
    s_add_u32 m0, s19, 24576
    s_add_u32 s27, s22, 106496
    buffer_load_dwordx4 v1, s[12:15], s27 offen offset:0 lds
    ds_read_b128 a[120:123], v238 offset:32768
    s_waitcnt lgkmcnt(5)
    v_mfma_f32_32x32x16_bf16 v[16:31], a[96:99], a[64:67], v[16:31]
    ds_read_b128 a[124:127], v239 offset:32768
    v_mfma_f32_32x32x16_bf16 v[16:31], a[100:103], a[68:71], v[16:31]
    buffer_load_dwordx4 v1, s[12:15], s27 offen offset:1024 lds
    s_waitcnt lgkmcnt(4)
    v_mfma_f32_32x32x16_bf16 v[16:31], a[104:107], a[72:75], v[16:31]
    v_mfma_f32_32x32x16_bf16 v[16:31], a[108:111], a[76:79], v[16:31]
    buffer_load_dwordx4 v1, s[12:15], s27 offen offset:2048 lds
    s_waitcnt lgkmcnt(2)
    v_mfma_f32_32x32x16_bf16 v[16:31], a[112:115], a[80:83], v[16:31]
    v_mfma_f32_32x32x16_bf16 v[16:31], a[116:119], a[84:87], v[16:31]
    buffer_load_dwordx4 v1, s[12:15], s27 offen offset:3072 lds
    s_waitcnt lgkmcnt(0)
    v_mfma_f32_32x32x16_bf16 v[16:31], a[120:123], a[88:91], v[16:31]
    v_mfma_f32_32x32x16_bf16 v[16:31], a[124:127], a[92:95], v[16:31]
    s_add_u32 m0, s19, 28672
    s_add_u32 s27, s22, 110592
    buffer_load_dwordx4 v1, s[12:15], s27 offen offset:0 lds
    ds_read_b64_tr_b16 a[128:129], v240 offset:32768
    ds_read_b64_tr_b16 a[130:131], v241 offset:32768
    ds_read_b64_tr_b16 a[132:133], v242 offset:32768
    ds_read_b64_tr_b16 a[134:135], v243 offset:32768
    ds_read_b64_tr_b16 a[136:137], v244 offset:32768
    ds_read_b64_tr_b16 a[138:139], v245 offset:32768
    ds_read_b64_tr_b16 a[140:141], v246 offset:32768
    ds_read_b64_tr_b16 a[142:143], v247 offset:32768
    ds_read_b64_tr_b16 a[144:145], v240 offset:0
    ds_read_b64_tr_b16 a[146:147], v241 offset:0
    ds_read_b64_tr_b16 a[148:149], v242 offset:0
    ds_read_b64_tr_b16 a[150:151], v243 offset:0
    v_max3_f32 v11, v16, v17, v18
    v_max3_f32 v12, v19, v20, v21
    v_max3_f32 v11, v11, v22, v23
    buffer_load_dwordx4 v1, s[12:15], s27 offen offset:1024 lds
    v_max3_f32 v12, v12, v24, v25
    v_max3_f32 v11, v11, v26, v27
    v_max3_f32 v12, v12, v28, v29
    v_max3_f32 v11, v11, v30, v31
    v_max_f32 v11, v11, v12
    v_mov_b32 v12, v11
    s_nop 1
    v_permlane32_swap_b32 v11, v12
    v_max_f32 v11, v11, v12
    v_mov_b32 v6, v11
    v_sub_f32 v16, v16, v6
    v_sub_f32 v17, v17, v6
    v_sub_f32 v18, v18, v6
    v_sub_f32 v19, v19, v6
    buffer_load_dwordx4 v1, s[12:15], s27 offen offset:2048 lds
    v_sub_f32 v20, v20, v6
    v_sub_f32 v21, v21, v6
    v_sub_f32 v22, v22, v6
    v_sub_f32 v23, v23, v6
    v_exp_f32 v16, v16
    v_exp_f32 v17, v17
    v_exp_f32 v18, v18
    v_exp_f32 v19, v19
    v_exp_f32 v20, v20
    v_exp_f32 v21, v21
    buffer_load_dwordx4 v1, s[12:15], s27 offen offset:3072 lds
    v_exp_f32 v22, v22
    v_exp_f32 v23, v23
    v_cvt_pk_bf16_f32 v32, v16, v17
    v_cvt_pk_bf16_f32 v33, v18, v19
    v_cvt_pk_bf16_f32 v34, v20, v21
    v_cvt_pk_bf16_f32 v35, v22, v23
    ds_read_b64_tr_b16 a[152:153], v244 offset:0
    ds_read_b64_tr_b16 a[154:155], v245 offset:0
    s_waitcnt lgkmcnt(10)
    v_mfma_f32_32x32x16_bf16 v[168:183], a[128:131], v[32:35], 0
    v_sub_f32 v24, v24, v6
    v_sub_f32 v25, v25, v6
    v_sub_f32 v26, v26, v6
    v_sub_f32 v27, v27, v6
    ds_read_b64_tr_b16 a[156:157], v246 offset:0
    ds_read_b64_tr_b16 a[158:159], v247 offset:0
    v_mfma_f32_32x32x16_bf16 v[184:199], a[132:135], v[32:35], 0
    v_sub_f32 v28, v28, v6
    v_sub_f32 v29, v29, v6
    v_sub_f32 v30, v30, v6
    v_sub_f32 v31, v31, v6
    ds_read_b64_tr_b16 a[128:129], v240 offset:8192
    ds_read_b64_tr_b16 a[130:131], v241 offset:8192
    s_waitcnt lgkmcnt(10)
    v_mfma_f32_32x32x16_bf16 v[200:215], a[136:139], v[32:35], 0
    v_exp_f32 v24, v24
    v_exp_f32 v25, v25
    v_exp_f32 v26, v26
    v_exp_f32 v27, v27
    ds_read_b64_tr_b16 a[132:133], v242 offset:8192
    ds_read_b64_tr_b16 a[134:135], v243 offset:8192
    v_mfma_f32_32x32x16_bf16 v[216:231], a[140:143], v[32:35], 0
    v_exp_f32 v28, v28
    v_exp_f32 v29, v29
    v_exp_f32 v30, v30
    v_exp_f32 v31, v31
    ds_read_b64_tr_b16 a[136:137], v244 offset:8192
    ds_read_b64_tr_b16 a[138:139], v245 offset:8192
    s_waitcnt lgkmcnt(10)
    v_mfma_f32_32x32x16_bf16 v[40:55], a[144:147], v[32:35], 0
    v_cvt_pk_bf16_f32 v36, v24, v25
    v_cvt_pk_bf16_f32 v37, v26, v27
    v_cvt_pk_bf16_f32 v38, v28, v29
    v_cvt_pk_bf16_f32 v39, v30, v31
    ds_read_b64_tr_b16 a[140:141], v246 offset:8192
    ds_read_b64_tr_b16 a[142:143], v247 offset:8192
    v_mfma_f32_32x32x16_bf16 v[56:71], a[148:151], v[32:35], 0
    v_add_f32 v11, v16, v17
    v_add_f32 v12, v18, v19
    v_add_f32 v11, v11, v20
    v_add_f32 v12, v12, v21
    ds_read_b64_tr_b16 a[144:145], v240 offset:36864
    ds_read_b64_tr_b16 a[146:147], v241 offset:36864
    s_waitcnt lgkmcnt(10)
    v_mfma_f32_32x32x16_bf16 v[72:87], a[152:155], v[32:35], 0
    v_add_f32 v11, v11, v22
    v_add_f32 v12, v12, v23
    v_add_f32 v11, v11, v24
    v_add_f32 v12, v12, v25
    ds_read_b64_tr_b16 a[148:149], v242 offset:36864
    ds_read_b64_tr_b16 a[150:151], v243 offset:36864
    v_mfma_f32_32x32x16_bf16 v[88:103], a[156:159], v[32:35], 0
    v_add_f32 v11, v11, v26
    v_add_f32 v12, v12, v27
    v_add_f32 v11, v11, v28
    v_add_f32 v12, v12, v29
    ds_read_b64_tr_b16 a[152:153], v244 offset:36864
    ds_read_b64_tr_b16 a[154:155], v245 offset:36864
    s_waitcnt lgkmcnt(10)
    v_mfma_f32_32x32x16_bf16 v[104:119], a[128:131], v[32:35], 0
    v_add_f32 v11, v11, v30
    v_add_f32 v12, v12, v31
    v_add_f32 v11, v11, v12
    v_add_f32 v7, v7, v11
    ds_read_b64_tr_b16 a[156:157], v246 offset:36864
    ds_read_b64_tr_b16 a[158:159], v247 offset:36864
    v_mfma_f32_32x32x16_bf16 v[120:135], a[132:135], v[32:35], 0
    ds_read_b64_tr_b16 a[128:129], v240 offset:4096
    ds_read_b64_tr_b16 a[130:131], v241 offset:4096
    s_waitcnt lgkmcnt(10)
    v_mfma_f32_32x32x16_bf16 v[136:151], a[136:139], v[32:35], 0
    ds_read_b64_tr_b16 a[132:133], v242 offset:4096
    ds_read_b64_tr_b16 a[134:135], v243 offset:4096
    v_mfma_f32_32x32x16_bf16 v[152:167], a[140:143], v[32:35], 0
    ds_read_b64_tr_b16 a[136:137], v244 offset:4096
    ds_read_b64_tr_b16 a[138:139], v245 offset:4096
    s_waitcnt lgkmcnt(10)
    v_mfma_f32_32x32x16_bf16 v[168:183], a[144:147], v[36:39], v[168:183]
    ds_read_b64_tr_b16 a[140:141], v246 offset:4096
    ds_read_b64_tr_b16 a[142:143], v247 offset:4096
    v_mfma_f32_32x32x16_bf16 v[184:199], a[148:151], v[36:39], v[184:199]
    ds_read_b64_tr_b16 a[144:145], v240 offset:12288
    ds_read_b64_tr_b16 a[146:147], v241 offset:12288
    s_waitcnt lgkmcnt(10)
    v_mfma_f32_32x32x16_bf16 v[200:215], a[152:155], v[36:39], v[200:215]
    ds_read_b64_tr_b16 a[148:149], v242 offset:12288
    ds_read_b64_tr_b16 a[150:151], v243 offset:12288
    v_mfma_f32_32x32x16_bf16 v[216:231], a[156:159], v[36:39], v[216:231]
    ds_read_b64_tr_b16 a[152:153], v244 offset:12288
    s_add_u32 m0, s19, 32768
    s_add_u32 s27, s22, 114688
    buffer_load_dwordx4 v1, s[12:15], s27 offen offset:0 lds
    ds_read_b64_tr_b16 a[154:155], v245 offset:12288
    s_waitcnt lgkmcnt(10)
    v_mfma_f32_32x32x16_bf16 v[40:55], a[128:131], v[36:39], v[40:55]
    buffer_load_dwordx4 v1, s[12:15], s27 offen offset:1024 lds
    ds_read_b64_tr_b16 a[156:157], v246 offset:12288
    ds_read_b64_tr_b16 a[158:159], v247 offset:12288
    v_mfma_f32_32x32x16_bf16 v[56:71], a[132:135], v[36:39], v[56:71]
    buffer_load_dwordx4 v1, s[12:15], s27 offen offset:2048 lds
    s_waitcnt lgkmcnt(8)
    v_mfma_f32_32x32x16_bf16 v[72:87], a[136:139], v[36:39], v[72:87]
    buffer_load_dwordx4 v1, s[12:15], s27 offen offset:3072 lds
    v_mfma_f32_32x32x16_bf16 v[88:103], a[140:143], v[36:39], v[88:103]
    s_add_u32 m0, s19, 36864
    s_add_u32 s27, s22, 118784
    buffer_load_dwordx4 v1, s[12:15], s27 offen offset:0 lds
    s_waitcnt lgkmcnt(4)
    v_mfma_f32_32x32x16_bf16 v[104:119], a[144:147], v[36:39], v[104:119]
    buffer_load_dwordx4 v1, s[12:15], s27 offen offset:1024 lds
    s_waitcnt vmcnt(6)
    ds_read_b128 a[96:99], v232 offset:16384
    ds_read_b128 a[100:103], v233 offset:16384
    ds_read_b128 a[104:107], v234 offset:16384
    ds_read_b128 a[108:111], v235 offset:16384
    ds_read_b128 a[112:115], v236 offset:16384
    ds_read_b128 a[116:119], v237 offset:16384
    v_mfma_f32_32x32x16_bf16 v[120:135], a[148:151], v[36:39], v[120:135]
    buffer_load_dwordx4 v1, s[12:15], s27 offen offset:2048 lds
    s_waitcnt lgkmcnt(6)
    v_mfma_f32_32x32x16_bf16 v[136:151], a[152:155], v[36:39], v[136:151]
    buffer_load_dwordx4 v1, s[12:15], s27 offen offset:3072 lds
    v_mfma_f32_32x32x16_bf16 v[152:167], a[156:159], v[36:39], v[152:167]
    ds_read_b128 a[120:123], v238 offset:16384
    s_add_u32 m0, s19, 0
    s_add_u32 s27, s22, 196608
    buffer_load_dwordx4 v1, s[12:15], s27 offen offset:0 lds
    s_waitcnt lgkmcnt(5)
    v_mfma_f32_32x32x16_bf16 v[16:31], a[96:99], a[0:3], 0
    ds_read_b128 a[124:127], v239 offset:16384
    v_mfma_f32_32x32x16_bf16 v[16:31], a[100:103], a[4:7], v[16:31]
    buffer_load_dwordx4 v1, s[12:15], s27 offen offset:1024 lds
    ds_read_b128 a[96:99], v232 offset:24576
    s_waitcnt lgkmcnt(5)
    v_mfma_f32_32x32x16_bf16 v[16:31], a[104:107], a[8:11], v[16:31]
    ds_read_b128 a[100:103], v233 offset:24576
    v_mfma_f32_32x32x16_bf16 v[16:31], a[108:111], a[12:15], v[16:31]
    buffer_load_dwordx4 v1, s[12:15], s27 offen offset:2048 lds
    ds_read_b128 a[104:107], v234 offset:24576
    s_waitcnt lgkmcnt(5)
    v_mfma_f32_32x32x16_bf16 v[16:31], a[112:115], a[16:19], v[16:31]
    ds_read_b128 a[108:111], v235 offset:24576
    v_mfma_f32_32x32x16_bf16 v[16:31], a[116:119], a[20:23], v[16:31]
    buffer_load_dwordx4 v1, s[12:15], s27 offen offset:3072 lds
    ds_read_b128 a[112:115], v236 offset:24576
    s_waitcnt lgkmcnt(5)
    v_mfma_f32_32x32x16_bf16 v[16:31], a[120:123], a[24:27], v[16:31]
    ds_read_b128 a[116:119], v237 offset:24576
    v_mfma_f32_32x32x16_bf16 v[16:31], a[124:127], a[28:31], v[16:31]
    s_add_u32 m0, s19, 4096
    s_add_u32 s27, s22, 200704
    buffer_load_dwordx4 v1, s[12:15], s27 offen offset:0 lds
    ds_read_b128 a[120:123], v238 offset:24576
    s_waitcnt lgkmcnt(5)
    v_mfma_f32_32x32x16_bf16 v[16:31], a[96:99], a[32:35], v[16:31]
    ds_read_b128 a[124:127], v239 offset:24576
    v_mfma_f32_32x32x16_bf16 v[16:31], a[100:103], a[36:39], v[16:31]
    buffer_load_dwordx4 v1, s[12:15], s27 offen offset:1024 lds
    s_waitcnt vmcnt(6)
    ds_read_b128 a[96:99], v232 offset:32768
    s_waitcnt lgkmcnt(5)
    v_mfma_f32_32x32x16_bf16 v[16:31], a[104:107], a[40:43], v[16:31]
    ds_read_b128 a[100:103], v233 offset:32768
    v_mfma_f32_32x32x16_bf16 v[16:31], a[108:111], a[44:47], v[16:31]
    buffer_load_dwordx4 v1, s[12:15], s27 offen offset:2048 lds
    ds_read_b128 a[104:107], v234 offset:32768
    s_waitcnt lgkmcnt(5)
    v_mfma_f32_32x32x16_bf16 v[16:31], a[112:115], a[48:51], v[16:31]
    ds_read_b128 a[108:111], v235 offset:32768
    v_mfma_f32_32x32x16_bf16 v[16:31], a[116:119], a[52:55], v[16:31]
    buffer_load_dwordx4 v1, s[12:15], s27 offen offset:3072 lds
    ds_read_b128 a[112:115], v236 offset:32768
    s_waitcnt lgkmcnt(5)
    v_mfma_f32_32x32x16_bf16 v[16:31], a[120:123], a[56:59], v[16:31]
    ds_read_b128 a[116:119], v237 offset:32768
    v_mfma_f32_32x32x16_bf16 v[16:31], a[124:127], a[60:63], v[16:31]
    s_add_u32 m0, s19, 8192
    s_add_u32 s27, s22, 204800
    buffer_load_dwordx4 v1, s[12:15], s27 offen offset:0 lds
    ds_read_b128 a[120:123], v238 offset:32768
    s_waitcnt lgkmcnt(5)
    v_mfma_f32_32x32x16_bf16 v[16:31], a[96:99], a[64:67], v[16:31]
    ds_read_b128 a[124:127], v239 offset:32768
    v_mfma_f32_32x32x16_bf16 v[16:31], a[100:103], a[68:71], v[16:31]
    buffer_load_dwordx4 v1, s[12:15], s27 offen offset:1024 lds
    s_waitcnt lgkmcnt(4)
    v_mfma_f32_32x32x16_bf16 v[16:31], a[104:107], a[72:75], v[16:31]
    v_mfma_f32_32x32x16_bf16 v[16:31], a[108:111], a[76:79], v[16:31]
    buffer_load_dwordx4 v1, s[12:15], s27 offen offset:2048 lds
    s_waitcnt lgkmcnt(2)
    v_mfma_f32_32x32x16_bf16 v[16:31], a[112:115], a[80:83], v[16:31]
    v_mfma_f32_32x32x16_bf16 v[16:31], a[116:119], a[84:87], v[16:31]
    buffer_load_dwordx4 v1, s[12:15], s27 offen offset:3072 lds
    s_waitcnt lgkmcnt(0)
    v_mfma_f32_32x32x16_bf16 v[16:31], a[120:123], a[88:91], v[16:31]
    v_mfma_f32_32x32x16_bf16 v[16:31], a[124:127], a[92:95], v[16:31]
    s_add_u32 m0, s19, 12288
    s_add_u32 s27, s22, 208896
    buffer_load_dwordx4 v1, s[12:15], s27 offen offset:0 lds
    ds_read_b64_tr_b16 a[128:129], v240 offset:32768
    ds_read_b64_tr_b16 a[130:131], v241 offset:32768
    ds_read_b64_tr_b16 a[132:133], v242 offset:32768
    ds_read_b64_tr_b16 a[134:135], v243 offset:32768
    ds_read_b64_tr_b16 a[136:137], v244 offset:32768
    ds_read_b64_tr_b16 a[138:139], v245 offset:32768
    ds_read_b64_tr_b16 a[140:141], v246 offset:32768
    ds_read_b64_tr_b16 a[142:143], v247 offset:32768
    ds_read_b64_tr_b16 a[144:145], v240 offset:16384
    ds_read_b64_tr_b16 a[146:147], v241 offset:16384
    ds_read_b64_tr_b16 a[148:149], v242 offset:16384
    ds_read_b64_tr_b16 a[150:151], v243 offset:16384
    v_max3_f32 v11, v16, v17, v18
    v_max3_f32 v12, v19, v20, v21
    v_max3_f32 v11, v11, v22, v23
    buffer_load_dwordx4 v1, s[12:15], s27 offen offset:1024 lds
    v_max3_f32 v12, v12, v24, v25
    v_max3_f32 v11, v11, v26, v27
    v_max3_f32 v12, v12, v28, v29
    v_max3_f32 v11, v11, v30, v31
    v_max_f32 v11, v11, v12
    v_mov_b32 v12, v11
    s_nop 1
    v_permlane32_swap_b32 v11, v12
    v_max_f32 v11, v11, v12
    v_sub_f32 v12, v11, v6
    v_cmp_lt_f32 vcc, s24, v12
    s_nop 1
    s_cbranch_vccz K2_NORESC_1
    v_max_f32 v11, v11, v6
    v_sub_f32 v12, v6, v11
    v_exp_f32 v12, v12
    v_mov_b32 v6, v11
    v_mul_f32 v7, v7, v12
    v_mul_f32 v40, v40, v12
    v_mul_f32 v41, v41, v12
    v_mul_f32 v42, v42, v12
    v_mul_f32 v43, v43, v12
    v_mul_f32 v44, v44, v12
    v_mul_f32 v45, v45, v12
    v_mul_f32 v46, v46, v12
    v_mul_f32 v47, v47, v12
    v_mul_f32 v48, v48, v12
    v_mul_f32 v49, v49, v12
    v_mul_f32 v50, v50, v12
    v_mul_f32 v51, v51, v12
    v_mul_f32 v52, v52, v12
    v_mul_f32 v53, v53, v12
    v_mul_f32 v54, v54, v12
    v_mul_f32 v55, v55, v12
    v_mul_f32 v56, v56, v12
    v_mul_f32 v57, v57, v12
    v_mul_f32 v58, v58, v12
    v_mul_f32 v59, v59, v12
    v_mul_f32 v60, v60, v12
    v_mul_f32 v61, v61, v12
    v_mul_f32 v62, v62, v12
    v_mul_f32 v63, v63, v12
    v_mul_f32 v64, v64, v12
    v_mul_f32 v65, v65, v12
    v_mul_f32 v66, v66, v12
    v_mul_f32 v67, v67, v12
    v_mul_f32 v68, v68, v12
    v_mul_f32 v69, v69, v12
    v_mul_f32 v70, v70, v12
    v_mul_f32 v71, v71, v12
    v_mul_f32 v72, v72, v12
    v_mul_f32 v73, v73, v12
    v_mul_f32 v74, v74, v12
    v_mul_f32 v75, v75, v12
    v_mul_f32 v76, v76, v12
    v_mul_f32 v77, v77, v12
    v_mul_f32 v78, v78, v12
    v_mul_f32 v79, v79, v12
    v_mul_f32 v80, v80, v12
    v_mul_f32 v81, v81, v12
    v_mul_f32 v82, v82, v12
    v_mul_f32 v83, v83, v12
    v_mul_f32 v84, v84, v12
    v_mul_f32 v85, v85, v12
    v_mul_f32 v86, v86, v12
    v_mul_f32 v87, v87, v12
    v_mul_f32 v88, v88, v12
    v_mul_f32 v89, v89, v12
    v_mul_f32 v90, v90, v12
    v_mul_f32 v91, v91, v12
    v_mul_f32 v92, v92, v12
    v_mul_f32 v93, v93, v12
    v_mul_f32 v94, v94, v12
    v_mul_f32 v95, v95, v12
    v_mul_f32 v96, v96, v12
    v_mul_f32 v97, v97, v12
    v_mul_f32 v98, v98, v12
    v_mul_f32 v99, v99, v12
    v_mul_f32 v100, v100, v12
    v_mul_f32 v101, v101, v12
    v_mul_f32 v102, v102, v12
    v_mul_f32 v103, v103, v12
    v_mul_f32 v104, v104, v12
    v_mul_f32 v105, v105, v12
    v_mul_f32 v106, v106, v12
    v_mul_f32 v107, v107, v12
    v_mul_f32 v108, v108, v12
    v_mul_f32 v109, v109, v12
    v_mul_f32 v110, v110, v12
    v_mul_f32 v111, v111, v12
    v_mul_f32 v112, v112, v12
    v_mul_f32 v113, v113, v12
    v_mul_f32 v114, v114, v12
    v_mul_f32 v115, v115, v12
    v_mul_f32 v116, v116, v12
    v_mul_f32 v117, v117, v12
    v_mul_f32 v118, v118, v12
    v_mul_f32 v119, v119, v12
    v_mul_f32 v120, v120, v12
    v_mul_f32 v121, v121, v12
    v_mul_f32 v122, v122, v12
    v_mul_f32 v123, v123, v12
    v_mul_f32 v124, v124, v12
    v_mul_f32 v125, v125, v12
    v_mul_f32 v126, v126, v12
    v_mul_f32 v127, v127, v12
    v_mul_f32 v128, v128, v12
    v_mul_f32 v129, v129, v12
    v_mul_f32 v130, v130, v12
    v_mul_f32 v131, v131, v12
    v_mul_f32 v132, v132, v12
    v_mul_f32 v133, v133, v12
    v_mul_f32 v134, v134, v12
    v_mul_f32 v135, v135, v12
    v_mul_f32 v136, v136, v12
    v_mul_f32 v137, v137, v12
    v_mul_f32 v138, v138, v12
    v_mul_f32 v139, v139, v12
    v_mul_f32 v140, v140, v12
    v_mul_f32 v141, v141, v12
    v_mul_f32 v142, v142, v12
    v_mul_f32 v143, v143, v12
    v_mul_f32 v144, v144, v12
    v_mul_f32 v145, v145, v12
    v_mul_f32 v146, v146, v12
    v_mul_f32 v147, v147, v12
    v_mul_f32 v148, v148, v12
    v_mul_f32 v149, v149, v12
    v_mul_f32 v150, v150, v12
    v_mul_f32 v151, v151, v12
    v_mul_f32 v152, v152, v12
    v_mul_f32 v153, v153, v12
    v_mul_f32 v154, v154, v12
    v_mul_f32 v155, v155, v12
    v_mul_f32 v156, v156, v12
    v_mul_f32 v157, v157, v12
    v_mul_f32 v158, v158, v12
    v_mul_f32 v159, v159, v12
    v_mul_f32 v160, v160, v12
    v_mul_f32 v161, v161, v12
    v_mul_f32 v162, v162, v12
    v_mul_f32 v163, v163, v12
    v_mul_f32 v164, v164, v12
    v_mul_f32 v165, v165, v12
    v_mul_f32 v166, v166, v12
    v_mul_f32 v167, v167, v12
    v_mul_f32 v168, v168, v12
    v_mul_f32 v169, v169, v12
    v_mul_f32 v170, v170, v12
    v_mul_f32 v171, v171, v12
    v_mul_f32 v172, v172, v12
    v_mul_f32 v173, v173, v12
    v_mul_f32 v174, v174, v12
    v_mul_f32 v175, v175, v12
    v_mul_f32 v176, v176, v12
    v_mul_f32 v177, v177, v12
    v_mul_f32 v178, v178, v12
    v_mul_f32 v179, v179, v12
    v_mul_f32 v180, v180, v12
    v_mul_f32 v181, v181, v12
    v_mul_f32 v182, v182, v12
    v_mul_f32 v183, v183, v12
    v_mul_f32 v184, v184, v12
    v_mul_f32 v185, v185, v12
    v_mul_f32 v186, v186, v12
    v_mul_f32 v187, v187, v12
    v_mul_f32 v188, v188, v12
    v_mul_f32 v189, v189, v12
    v_mul_f32 v190, v190, v12
    v_mul_f32 v191, v191, v12
    v_mul_f32 v192, v192, v12
    v_mul_f32 v193, v193, v12
    v_mul_f32 v194, v194, v12
    v_mul_f32 v195, v195, v12
    v_mul_f32 v196, v196, v12
    v_mul_f32 v197, v197, v12
    v_mul_f32 v198, v198, v12
    v_mul_f32 v199, v199, v12
    v_mul_f32 v200, v200, v12
    v_mul_f32 v201, v201, v12
    v_mul_f32 v202, v202, v12
    v_mul_f32 v203, v203, v12
    v_mul_f32 v204, v204, v12
    v_mul_f32 v205, v205, v12
    v_mul_f32 v206, v206, v12
    v_mul_f32 v207, v207, v12
    v_mul_f32 v208, v208, v12
    v_mul_f32 v209, v209, v12
    v_mul_f32 v210, v210, v12
    v_mul_f32 v211, v211, v12
    v_mul_f32 v212, v212, v12
    v_mul_f32 v213, v213, v12
    v_mul_f32 v214, v214, v12
    v_mul_f32 v215, v215, v12
    v_mul_f32 v216, v216, v12
    v_mul_f32 v217, v217, v12
    v_mul_f32 v218, v218, v12
    v_mul_f32 v219, v219, v12
    v_mul_f32 v220, v220, v12
    v_mul_f32 v221, v221, v12
    v_mul_f32 v222, v222, v12
    v_mul_f32 v223, v223, v12
    v_mul_f32 v224, v224, v12
    v_mul_f32 v225, v225, v12
    v_mul_f32 v226, v226, v12
    v_mul_f32 v227, v227, v12
    v_mul_f32 v228, v228, v12
    v_mul_f32 v229, v229, v12
    v_mul_f32 v230, v230, v12
    v_mul_f32 v231, v231, v12
    s_nop 3
K2_NORESC_1:
    v_sub_f32 v16, v16, v6
    buffer_load_dwordx4 v1, s[12:15], s27 offen offset:2048 lds
    v_sub_f32 v17, v17, v6
    v_sub_f32 v18, v18, v6
    v_sub_f32 v19, v19, v6
    v_sub_f32 v20, v20, v6
    v_sub_f32 v21, v21, v6
    v_sub_f32 v22, v22, v6
    v_sub_f32 v23, v23, v6
    v_exp_f32 v16, v16
    v_exp_f32 v17, v17
    v_exp_f32 v18, v18
    v_exp_f32 v19, v19
    buffer_load_dwordx4 v1, s[12:15], s27 offen offset:3072 lds
    v_exp_f32 v20, v20
    v_exp_f32 v21, v21
    v_exp_f32 v22, v22
    v_exp_f32 v23, v23
    v_cvt_pk_bf16_f32 v32, v16, v17
    v_cvt_pk_bf16_f32 v33, v18, v19
    v_cvt_pk_bf16_f32 v34, v20, v21
    v_cvt_pk_bf16_f32 v35, v22, v23
    ds_read_b64_tr_b16 a[152:153], v244 offset:16384
    ds_read_b64_tr_b16 a[154:155], v245 offset:16384
    s_waitcnt lgkmcnt(10)
    s_add_u32 s29, s28, 884736
    buffer_load_dwordx4 a[160:163], v1, s[12:15], s29 offen
    v_mfma_f32_32x32x16_bf16 v[168:183], a[128:131], v[32:35], v[168:183]
    v_sub_f32 v24, v24, v6
    v_sub_f32 v25, v25, v6
    v_sub_f32 v26, v26, v6
    v_sub_f32 v27, v27, v6
    ds_read_b64_tr_b16 a[156:157], v246 offset:16384
    ds_read_b64_tr_b16 a[158:159], v247 offset:16384
    v_mfma_f32_32x32x16_bf16 v[184:199], a[132:135], v[32:35], v[184:199]
    s_add_u32 s29, s28, 885760
    buffer_load_dwordx4 a[164:167], v1, s[12:15], s29 offen
    v_sub_f32 v28, v28, v6
    v_sub_f32 v29, v29, v6
    v_sub_f32 v30, v30, v6
    v_sub_f32 v31, v31, v6
    ds_read_b64_tr_b16 a[128:129], v240 offset:24576
    ds_read_b64_tr_b16 a[130:131], v241 offset:24576
    s_waitcnt lgkmcnt(10)
    v_mfma_f32_32x32x16_bf16 v[200:215], a[136:139], v[32:35], v[200:215]
    s_add_u32 s29, s28, 886784
    buffer_load_dwordx4 a[168:171], v1, s[12:15], s29 offen
    v_exp_f32 v24, v24
    v_exp_f32 v25, v25
    v_exp_f32 v26, v26
    v_exp_f32 v27, v27
    ds_read_b64_tr_b16 a[132:133], v242 offset:24576
    ds_read_b64_tr_b16 a[134:135], v243 offset:24576
    v_mfma_f32_32x32x16_bf16 v[216:231], a[140:143], v[32:35], v[216:231]
    s_add_u32 s29, s28, 887808
    buffer_load_dwordx4 a[172:175], v1, s[12:15], s29 offen
    v_exp_f32 v28, v28
    v_exp_f32 v29, v29
    v_exp_f32 v30, v30
    v_exp_f32 v31, v31
    ds_read_b64_tr_b16 a[136:137], v244 offset:24576
    ds_read_b64_tr_b16 a[138:139], v245 offset:24576
    s_waitcnt lgkmcnt(10)
    v_mfma_f32_32x32x16_bf16 v[40:55], a[144:147], v[32:35], v[40:55]
    s_add_u32 s29, s28, 888832
    buffer_load_dwordx4 a[176:179], v1, s[12:15], s29 offen
    v_cvt_pk_bf16_f32 v36, v24, v25
    v_cvt_pk_bf16_f32 v37, v26, v27
    v_cvt_pk_bf16_f32 v38, v28, v29
    v_cvt_pk_bf16_f32 v39, v30, v31
    ds_read_b64_tr_b16 a[140:141], v246 offset:24576
    ds_read_b64_tr_b16 a[142:143], v247 offset:24576
    v_mfma_f32_32x32x16_bf16 v[56:71], a[148:151], v[32:35], v[56:71]
    v_add_f32 v11, v16, v17
    s_add_u32 s29, s28, 889856
    buffer_load_dwordx4 a[180:183], v1, s[12:15], s29 offen
    v_add_f32 v12, v18, v19
    v_add_f32 v11, v11, v20
    v_add_f32 v12, v12, v21
    ds_read_b64_tr_b16 a[144:145], v240 offset:36864
    ds_read_b64_tr_b16 a[146:147], v241 offset:36864
    s_waitcnt lgkmcnt(10)
    v_mfma_f32_32x32x16_bf16 v[72:87], a[152:155], v[32:35], v[72:87]
    v_add_f32 v11, v11, v22
    v_add_f32 v12, v12, v23
    v_add_f32 v11, v11, v24
    v_add_f32 v12, v12, v25
    ds_read_b64_tr_b16 a[148:149], v242 offset:36864
    ds_read_b64_tr_b16 a[150:151], v243 offset:36864
    v_mfma_f32_32x32x16_bf16 v[88:103], a[156:159], v[32:35], v[88:103]
    v_add_f32 v11, v11, v26
    v_add_f32 v12, v12, v27
    v_add_f32 v11, v11, v28
    v_add_f32 v12, v12, v29
    ds_read_b64_tr_b16 a[152:153], v244 offset:36864
    ds_read_b64_tr_b16 a[154:155], v245 offset:36864
    s_waitcnt lgkmcnt(10)
    v_mfma_f32_32x32x16_bf16 v[104:119], a[128:131], v[32:35], v[104:119]
    v_add_f32 v11, v11, v30
    v_add_f32 v12, v12, v31
    v_add_f32 v11, v11, v12
    v_add_f32 v7, v7, v11
    ds_read_b64_tr_b16 a[156:157], v246 offset:36864
    ds_read_b64_tr_b16 a[158:159], v247 offset:36864
    v_mfma_f32_32x32x16_bf16 v[120:135], a[132:135], v[32:35], v[120:135]
    ds_read_b64_tr_b16 a[128:129], v240 offset:20480
    ds_read_b64_tr_b16 a[130:131], v241 offset:20480
    s_waitcnt lgkmcnt(10)
    v_mfma_f32_32x32x16_bf16 v[136:151], a[136:139], v[32:35], v[136:151]
    ds_read_b64_tr_b16 a[132:133], v242 offset:20480
    ds_read_b64_tr_b16 a[134:135], v243 offset:20480
    v_mfma_f32_32x32x16_bf16 v[152:167], a[140:143], v[32:35], v[152:167]
    ds_read_b64_tr_b16 a[136:137], v244 offset:20480
    ds_read_b64_tr_b16 a[138:139], v245 offset:20480
    s_waitcnt lgkmcnt(10)
    v_mfma_f32_32x32x16_bf16 v[168:183], a[144:147], v[36:39], v[168:183]
    ds_read_b64_tr_b16 a[140:141], v246 offset:20480
    ds_read_b64_tr_b16 a[142:143], v247 offset:20480
    v_mfma_f32_32x32x16_bf16 v[184:199], a[148:151], v[36:39], v[184:199]
    ds_read_b64_tr_b16 a[144:145], v240 offset:28672
    ds_read_b64_tr_b16 a[146:147], v241 offset:28672
    s_waitcnt lgkmcnt(10)
    v_mfma_f32_32x32x16_bf16 v[200:215], a[152:155], v[36:39], v[200:215]
    ds_read_b64_tr_b16 a[148:149], v242 offset:28672
    ds_read_b64_tr_b16 a[150:151], v243 offset:28672
    v_mfma_f32_32x32x16_bf16 v[216:231], a[156:159], v[36:39], v[216:231]
    ds_read_b64_tr_b16 a[152:153], v244 offset:28672
    s_add_u32 m0, s19, 32768
    s_add_u32 s27, s22, 212992
    buffer_load_dwordx4 v1, s[12:15], s27 offen offset:0 lds
    ds_read_b64_tr_b16 a[154:155], v245 offset:28672
    s_waitcnt lgkmcnt(10)
    v_mfma_f32_32x32x16_bf16 v[40:55], a[128:131], v[36:39], v[40:55]
    buffer_load_dwordx4 v1, s[12:15], s27 offen offset:1024 lds
    ds_read_b64_tr_b16 a[156:157], v246 offset:28672
    ds_read_b64_tr_b16 a[158:159], v247 offset:28672
    v_mfma_f32_32x32x16_bf16 v[56:71], a[132:135], v[36:39], v[56:71]
    buffer_load_dwordx4 v1, s[12:15], s27 offen offset:2048 lds
    s_waitcnt lgkmcnt(8)
    v_mfma_f32_32x32x16_bf16 v[72:87], a[136:139], v[36:39], v[72:87]
    buffer_load_dwordx4 v1, s[12:15], s27 offen offset:3072 lds
    v_mfma_f32_32x32x16_bf16 v[88:103], a[140:143], v[36:39], v[88:103]
    s_add_u32 m0, s19, 36864
    s_add_u32 s27, s22, 217088
    buffer_load_dwordx4 v1, s[12:15], s27 offen offset:0 lds
    s_waitcnt lgkmcnt(4)
    v_mfma_f32_32x32x16_bf16 v[104:119], a[144:147], v[36:39], v[104:119]
    buffer_load_dwordx4 v1, s[12:15], s27 offen offset:1024 lds
    s_waitcnt vmcnt(12)
    ds_read_b128 a[96:99], v232 offset:0
    ds_read_b128 a[100:103], v233 offset:0
    ds_read_b128 a[104:107], v234 offset:0
    ds_read_b128 a[108:111], v235 offset:0
    ds_read_b128 a[112:115], v236 offset:0
    ds_read_b128 a[116:119], v237 offset:0
    v_mfma_f32_32x32x16_bf16 v[120:135], a[148:151], v[36:39], v[120:135]
    buffer_load_dwordx4 v1, s[12:15], s27 offen offset:2048 lds
    s_waitcnt lgkmcnt(6)
    v_mfma_f32_32x32x16_bf16 v[136:151], a[152:155], v[36:39], v[136:151]
    buffer_load_dwordx4 v1, s[12:15], s27 offen offset:3072 lds
    v_mfma_f32_32x32x16_bf16 v[152:167], a[156:159], v[36:39], v[152:167]
    ds_read_b128 a[120:123], v238 offset:0
    s_add_u32 m0, s19, 16384
    s_add_u32 s27, s22, 294912
    buffer_load_dwordx4 v1, s[12:15], s27 offen offset:0 lds
    s_waitcnt lgkmcnt(5)
    v_mfma_f32_32x32x16_bf16 v[16:31], a[96:99], a[0:3], 0
    ds_read_b128 a[124:127], v239 offset:0
    v_mfma_f32_32x32x16_bf16 v[16:31], a[100:103], a[4:7], v[16:31]
    buffer_load_dwordx4 v1, s[12:15], s27 offen offset:1024 lds
    ds_read_b128 a[96:99], v232 offset:8192
    s_waitcnt lgkmcnt(5)
    v_mfma_f32_32x32x16_bf16 v[16:31], a[104:107], a[8:11], v[16:31]
    ds_read_b128 a[100:103], v233 offset:8192
    v_mfma_f32_32x32x16_bf16 v[16:31], a[108:111], a[12:15], v[16:31]
    buffer_load_dwordx4 v1, s[12:15], s27 offen offset:2048 lds
    ds_read_b128 a[104:107], v234 offset:8192
    s_waitcnt lgkmcnt(5)
    v_mfma_f32_32x32x16_bf16 v[16:31], a[112:115], a[16:19], v[16:31]
    ds_read_b128 a[108:111], v235 offset:8192
    v_mfma_f32_32x32x16_bf16 v[16:31], a[116:119], a[20:23], v[16:31]
    buffer_load_dwordx4 v1, s[12:15], s27 offen offset:3072 lds
    ds_read_b128 a[112:115], v236 offset:8192
    s_waitcnt lgkmcnt(5)
    v_mfma_f32_32x32x16_bf16 v[16:31], a[120:123], a[24:27], v[16:31]
    ds_read_b128 a[116:119], v237 offset:8192
    v_mfma_f32_32x32x16_bf16 v[16:31], a[124:127], a[28:31], v[16:31]
    s_add_u32 m0, s19, 20480
    s_add_u32 s27, s22, 299008
    buffer_load_dwordx4 v1, s[12:15], s27 offen offset:0 lds
    ds_read_b128 a[120:123], v238 offset:8192
    s_waitcnt lgkmcnt(5)
    v_mfma_f32_32x32x16_bf16 v[16:31], a[96:99], a[32:35], v[16:31]
    ds_read_b128 a[124:127], v239 offset:8192
    v_mfma_f32_32x32x16_bf16 v[16:31], a[100:103], a[36:39], v[16:31]
    buffer_load_dwordx4 v1, s[12:15], s27 offen offset:1024 lds
    s_waitcnt vmcnt(6)
    ds_read_b128 a[96:99], v232 offset:32768
    s_waitcnt lgkmcnt(5)
    v_mfma_f32_32x32x16_bf16 v[16:31], a[104:107], a[40:43], v[16:31]
    ds_read_b128 a[100:103], v233 offset:32768
    v_mfma_f32_32x32x16_bf16 v[16:31], a[108:111], a[44:47], v[16:31]
    buffer_load_dwordx4 v1, s[12:15], s27 offen offset:2048 lds
    ds_read_b128 a[104:107], v234 offset:32768
    s_waitcnt lgkmcnt(5)
    v_mfma_f32_32x32x16_bf16 v[16:31], a[112:115], a[48:51], v[16:31]
    ds_read_b128 a[108:111], v235 offset:32768
    v_mfma_f32_32x32x16_bf16 v[16:31], a[116:119], a[52:55], v[16:31]
    buffer_load_dwordx4 v1, s[12:15], s27 offen offset:3072 lds
    ds_read_b128 a[112:115], v236 offset:32768
    s_waitcnt lgkmcnt(5)
    v_mfma_f32_32x32x16_bf16 v[16:31], a[120:123], a[56:59], v[16:31]
    ds_read_b128 a[116:119], v237 offset:32768
    v_mfma_f32_32x32x16_bf16 v[16:31], a[124:127], a[60:63], v[16:31]
    s_add_u32 m0, s19, 24576
    s_add_u32 s27, s22, 303104
    buffer_load_dwordx4 v1, s[12:15], s27 offen offset:0 lds
    ds_read_b128 a[120:123], v238 offset:32768
    s_waitcnt lgkmcnt(5)
    v_mfma_f32_32x32x16_bf16 v[16:31], a[96:99], a[64:67], v[16:31]
    ds_read_b128 a[124:127], v239 offset:32768
    v_mfma_f32_32x32x16_bf16 v[16:31], a[100:103], a[68:71], v[16:31]
    buffer_load_dwordx4 v1, s[12:15], s27 offen offset:1024 lds
    s_waitcnt lgkmcnt(4)
    v_mfma_f32_32x32x16_bf16 v[16:31], a[104:107], a[72:75], v[16:31]
    v_mfma_f32_32x32x16_bf16 v[16:31], a[108:111], a[76:79], v[16:31]
    buffer_load_dwordx4 v1, s[12:15], s27 offen offset:2048 lds
    s_waitcnt lgkmcnt(2)
    v_mfma_f32_32x32x16_bf16 v[16:31], a[112:115], a[80:83], v[16:31]
    v_mfma_f32_32x32x16_bf16 v[16:31], a[116:119], a[84:87], v[16:31]
    buffer_load_dwordx4 v1, s[12:15], s27 offen offset:3072 lds
    s_waitcnt lgkmcnt(0)
    v_mfma_f32_32x32x16_bf16 v[16:31], a[120:123], a[88:91], v[16:31]
    v_mfma_f32_32x32x16_bf16 v[16:31], a[124:127], a[92:95], v[16:31]
    s_add_u32 m0, s19, 28672
    s_add_u32 s27, s22, 307200
    buffer_load_dwordx4 v1, s[12:15], s27 offen offset:0 lds
    ds_read_b64_tr_b16 a[128:129], v240 offset:32768
    ds_read_b64_tr_b16 a[130:131], v241 offset:32768
    ds_read_b64_tr_b16 a[132:133], v242 offset:32768
    ds_read_b64_tr_b16 a[134:135], v243 offset:32768
    ds_read_b64_tr_b16 a[136:137], v244 offset:32768
    ds_read_b64_tr_b16 a[138:139], v245 offset:32768
    ds_read_b64_tr_b16 a[140:141], v246 offset:32768
    ds_read_b64_tr_b16 a[142:143], v247 offset:32768
    ds_read_b64_tr_b16 a[144:145], v240 offset:0
    ds_read_b64_tr_b16 a[146:147], v241 offset:0
    ds_read_b64_tr_b16 a[148:149], v242 offset:0
    ds_read_b64_tr_b16 a[150:151], v243 offset:0
    v_max3_f32 v11, v16, v17, v18
    v_max3_f32 v12, v19, v20, v21
    v_max3_f32 v11, v11, v22, v23
    buffer_load_dwordx4 v1, s[12:15], s27 offen offset:1024 lds
    v_max3_f32 v12, v12, v24, v25
    v_max3_f32 v11, v11, v26, v27
    v_max3_f32 v12, v12, v28, v29
    v_max3_f32 v11, v11, v30, v31
    v_max_f32 v11, v11, v12
    v_mov_b32 v12, v11
    s_nop 1
    v_permlane32_swap_b32 v11, v12
    v_max_f32 v11, v11, v12
    v_sub_f32 v12, v11, v6
    v_cmp_lt_f32 vcc, s24, v12
    s_nop 1
    s_cbranch_vccz K2_NORESC_2
    v_max_f32 v11, v11, v6
    v_sub_f32 v12, v6, v11
    v_exp_f32 v12, v12
    v_mov_b32 v6, v11
    v_mul_f32 v7, v7, v12
    v_mul_f32 v40, v40, v12
    v_mul_f32 v41, v41, v12
    v_mul_f32 v42, v42, v12
    v_mul_f32 v43, v43, v12
    v_mul_f32 v44, v44, v12
    v_mul_f32 v45, v45, v12
    v_mul_f32 v46, v46, v12
    v_mul_f32 v47, v47, v12
    v_mul_f32 v48, v48, v12
    v_mul_f32 v49, v49, v12
    v_mul_f32 v50, v50, v12
    v_mul_f32 v51, v51, v12
    v_mul_f32 v52, v52, v12
    v_mul_f32 v53, v53, v12
    v_mul_f32 v54, v54, v12
    v_mul_f32 v55, v55, v12
    v_mul_f32 v56, v56, v12
    v_mul_f32 v57, v57, v12
    v_mul_f32 v58, v58, v12
    v_mul_f32 v59, v59, v12
    v_mul_f32 v60, v60, v12
    v_mul_f32 v61, v61, v12
    v_mul_f32 v62, v62, v12
    v_mul_f32 v63, v63, v12
    v_mul_f32 v64, v64, v12
    v_mul_f32 v65, v65, v12
    v_mul_f32 v66, v66, v12
    v_mul_f32 v67, v67, v12
    v_mul_f32 v68, v68, v12
    v_mul_f32 v69, v69, v12
    v_mul_f32 v70, v70, v12
    v_mul_f32 v71, v71, v12
    v_mul_f32 v72, v72, v12
    v_mul_f32 v73, v73, v12
    v_mul_f32 v74, v74, v12
    v_mul_f32 v75, v75, v12
    v_mul_f32 v76, v76, v12
    v_mul_f32 v77, v77, v12
    v_mul_f32 v78, v78, v12
    v_mul_f32 v79, v79, v12
    v_mul_f32 v80, v80, v12
    v_mul_f32 v81, v81, v12
    v_mul_f32 v82, v82, v12
    v_mul_f32 v83, v83, v12
    v_mul_f32 v84, v84, v12
    v_mul_f32 v85, v85, v12
    v_mul_f32 v86, v86, v12
    v_mul_f32 v87, v87, v12
    v_mul_f32 v88, v88, v12
    v_mul_f32 v89, v89, v12
    v_mul_f32 v90, v90, v12
    v_mul_f32 v91, v91, v12
    v_mul_f32 v92, v92, v12
    v_mul_f32 v93, v93, v12
    v_mul_f32 v94, v94, v12
    v_mul_f32 v95, v95, v12
    v_mul_f32 v96, v96, v12
    v_mul_f32 v97, v97, v12
    v_mul_f32 v98, v98, v12
    v_mul_f32 v99, v99, v12
    v_mul_f32 v100, v100, v12
    v_mul_f32 v101, v101, v12
    v_mul_f32 v102, v102, v12
    v_mul_f32 v103, v103, v12
    v_mul_f32 v104, v104, v12
    v_mul_f32 v105, v105, v12
    v_mul_f32 v106, v106, v12
    v_mul_f32 v107, v107, v12
    v_mul_f32 v108, v108, v12
    v_mul_f32 v109, v109, v12
    v_mul_f32 v110, v110, v12
    v_mul_f32 v111, v111, v12
    v_mul_f32 v112, v112, v12
    v_mul_f32 v113, v113, v12
    v_mul_f32 v114, v114, v12
    v_mul_f32 v115, v115, v12
    v_mul_f32 v116, v116, v12
    v_mul_f32 v117, v117, v12
    v_mul_f32 v118, v118, v12
    v_mul_f32 v119, v119, v12
    v_mul_f32 v120, v120, v12
    v_mul_f32 v121, v121, v12
    v_mul_f32 v122, v122, v12
    v_mul_f32 v123, v123, v12
    v_mul_f32 v124, v124, v12
    v_mul_f32 v125, v125, v12
    v_mul_f32 v126, v126, v12
    v_mul_f32 v127, v127, v12
    v_mul_f32 v128, v128, v12
    v_mul_f32 v129, v129, v12
    v_mul_f32 v130, v130, v12
    v_mul_f32 v131, v131, v12
    v_mul_f32 v132, v132, v12
    v_mul_f32 v133, v133, v12
    v_mul_f32 v134, v134, v12
    v_mul_f32 v135, v135, v12
    v_mul_f32 v136, v136, v12
    v_mul_f32 v137, v137, v12
    v_mul_f32 v138, v138, v12
    v_mul_f32 v139, v139, v12
    v_mul_f32 v140, v140, v12
    v_mul_f32 v141, v141, v12
    v_mul_f32 v142, v142, v12
    v_mul_f32 v143, v143, v12
    v_mul_f32 v144, v144, v12
    v_mul_f32 v145, v145, v12
    v_mul_f32 v146, v146, v12
    v_mul_f32 v147, v147, v12
    v_mul_f32 v148, v148, v12
    v_mul_f32 v149, v149, v12
    v_mul_f32 v150, v150, v12
    v_mul_f32 v151, v151, v12
    v_mul_f32 v152, v152, v12
    v_mul_f32 v153, v153, v12
    v_mul_f32 v154, v154, v12
    v_mul_f32 v155, v155, v12
    v_mul_f32 v156, v156, v12
    v_mul_f32 v157, v157, v12
    v_mul_f32 v158, v158, v12
    v_mul_f32 v159, v159, v12
    v_mul_f32 v160, v160, v12
    v_mul_f32 v161, v161, v12
    v_mul_f32 v162, v162, v12
    v_mul_f32 v163, v163, v12
    v_mul_f32 v164, v164, v12
    v_mul_f32 v165, v165, v12
    v_mul_f32 v166, v166, v12
    v_mul_f32 v167, v167, v12
    v_mul_f32 v168, v168, v12
    v_mul_f32 v169, v169, v12
    v_mul_f32 v170, v170, v12
    v_mul_f32 v171, v171, v12
    v_mul_f32 v172, v172, v12
    v_mul_f32 v173, v173, v12
    v_mul_f32 v174, v174, v12
    v_mul_f32 v175, v175, v12
    v_mul_f32 v176, v176, v12
    v_mul_f32 v177, v177, v12
    v_mul_f32 v178, v178, v12
    v_mul_f32 v179, v179, v12
    v_mul_f32 v180, v180, v12
    v_mul_f32 v181, v181, v12
    v_mul_f32 v182, v182, v12
    v_mul_f32 v183, v183, v12
    v_mul_f32 v184, v184, v12
    v_mul_f32 v185, v185, v12
    v_mul_f32 v186, v186, v12
    v_mul_f32 v187, v187, v12
    v_mul_f32 v188, v188, v12
    v_mul_f32 v189, v189, v12
    v_mul_f32 v190, v190, v12
    v_mul_f32 v191, v191, v12
    v_mul_f32 v192, v192, v12
    v_mul_f32 v193, v193, v12
    v_mul_f32 v194, v194, v12
    v_mul_f32 v195, v195, v12
    v_mul_f32 v196, v196, v12
    v_mul_f32 v197, v197, v12
    v_mul_f32 v198, v198, v12
    v_mul_f32 v199, v199, v12
    v_mul_f32 v200, v200, v12
    v_mul_f32 v201, v201, v12
    v_mul_f32 v202, v202, v12
    v_mul_f32 v203, v203, v12
    v_mul_f32 v204, v204, v12
    v_mul_f32 v205, v205, v12
    v_mul_f32 v206, v206, v12
    v_mul_f32 v207, v207, v12
    v_mul_f32 v208, v208, v12
    v_mul_f32 v209, v209, v12
    v_mul_f32 v210, v210, v12
    v_mul_f32 v211, v211, v12
    v_mul_f32 v212, v212, v12
    v_mul_f32 v213, v213, v12
    v_mul_f32 v214, v214, v12
    v_mul_f32 v215, v215, v12
    v_mul_f32 v216, v216, v12
    v_mul_f32 v217, v217, v12
    v_mul_f32 v218, v218, v12
    v_mul_f32 v219, v219, v12
    v_mul_f32 v220, v220, v12
    v_mul_f32 v221, v221, v12
    v_mul_f32 v222, v222, v12
    v_mul_f32 v223, v223, v12
    v_mul_f32 v224, v224, v12
    v_mul_f32 v225, v225, v12
    v_mul_f32 v226, v226, v12
    v_mul_f32 v227, v227, v12
    v_mul_f32 v228, v228, v12
    v_mul_f32 v229, v229, v12
    v_mul_f32 v230, v230, v12
    v_mul_f32 v231, v231, v12
    s_nop 3
K2_NORESC_2:
    v_sub_f32 v16, v16, v6
    buffer_load_dwordx4 v1, s[12:15], s27 offen offset:2048 lds
    v_sub_f32 v17, v17, v6
    v_sub_f32 v18, v18, v6
    v_sub_f32 v19, v19, v6
    v_sub_f32 v20, v20, v6
    v_sub_f32 v21, v21, v6
    v_sub_f32 v22, v22, v6
    v_sub_f32 v23, v23, v6
    v_exp_f32 v16, v16
    v_exp_f32 v17, v17
    v_exp_f32 v18, v18
    v_exp_f32 v19, v19
    buffer_load_dwordx4 v1, s[12:15], s27 offen offset:3072 lds
    v_exp_f32 v20, v20
    v_exp_f32 v21, v21
    v_exp_f32 v22, v22
    v_exp_f32 v23, v23
    v_cvt_pk_bf16_f32 v32, v16, v17
    v_cvt_pk_bf16_f32 v33, v18, v19
    v_cvt_pk_bf16_f32 v34, v20, v21
    v_cvt_pk_bf16_f32 v35, v22, v23
    ds_read_b64_tr_b16 a[152:153], v244 offset:0
    ds_read_b64_tr_b16 a[154:155], v245 offset:0
    s_waitcnt lgkmcnt(10)
    s_add_u32 s29, s28, 890880
    buffer_load_dwordx4 a[184:187], v1, s[12:15], s29 offen
    v_mfma_f32_32x32x16_bf16 v[168:183], a[128:131], v[32:35], v[168:183]
    v_sub_f32 v24, v24, v6
    v_sub_f32 v25, v25, v6
    v_sub_f32 v26, v26, v6
    v_sub_f32 v27, v27, v6
    ds_read_b64_tr_b16 a[156:157], v246 offset:0
    ds_read_b64_tr_b16 a[158:159], v247 offset:0
    v_mfma_f32_32x32x16_bf16 v[184:199], a[132:135], v[32:35], v[184:199]
    s_add_u32 s29, s28, 891904
    buffer_load_dwordx4 a[188:191], v1, s[12:15], s29 offen
    v_sub_f32 v28, v28, v6
    v_sub_f32 v29, v29, v6
    v_sub_f32 v30, v30, v6
    v_sub_f32 v31, v31, v6
    ds_read_b64_tr_b16 a[128:129], v240 offset:8192
    ds_read_b64_tr_b16 a[130:131], v241 offset:8192
    s_waitcnt lgkmcnt(10)
    v_mfma_f32_32x32x16_bf16 v[200:215], a[136:139], v[32:35], v[200:215]
    s_add_u32 s29, s28, 892928
    buffer_load_dwordx4 a[192:195], v1, s[12:15], s29 offen
    v_exp_f32 v24, v24
    v_exp_f32 v25, v25
    v_exp_f32 v26, v26
    v_exp_f32 v27, v27
    ds_read_b64_tr_b16 a[132:133], v242 offset:8192
    ds_read_b64_tr_b16 a[134:135], v243 offset:8192
    v_mfma_f32_32x32x16_bf16 v[216:231], a[140:143], v[32:35], v[216:231]
    s_add_u32 s29, s28, 893952
    buffer_load_dwordx4 a[196:199], v1, s[12:15], s29 offen
    v_exp_f32 v28, v28
    v_exp_f32 v29, v29
    v_exp_f32 v30, v30
    v_exp_f32 v31, v31
    ds_read_b64_tr_b16 a[136:137], v244 offset:8192
    ds_read_b64_tr_b16 a[138:139], v245 offset:8192
    s_waitcnt lgkmcnt(10)
    v_mfma_f32_32x32x16_bf16 v[40:55], a[144:147], v[32:35], v[40:55]
    s_add_u32 s29, s28, 894976
    buffer_load_dwordx4 a[200:203], v1, s[12:15], s29 offen
    v_cvt_pk_bf16_f32 v36, v24, v25
    v_cvt_pk_bf16_f32 v37, v26, v27
    v_cvt_pk_bf16_f32 v38, v28, v29
    v_cvt_pk_bf16_f32 v39, v30, v31
    ds_read_b64_tr_b16 a[140:141], v246 offset:8192
    ds_read_b64_tr_b16 a[142:143], v247 offset:8192
    v_mfma_f32_32x32x16_bf16 v[56:71], a[148:151], v[32:35], v[56:71]
    v_add_f32 v11, v16, v17
    s_add_u32 s29, s28, 896000
    buffer_load_dwordx4 a[204:207], v1, s[12:15], s29 offen
    v_add_f32 v12, v18, v19
    v_add_f32 v11, v11, v20
    v_add_f32 v12, v12, v21
    ds_read_b64_tr_b16 a[144:145], v240 offset:36864
    ds_read_b64_tr_b16 a[146:147], v241 offset:36864
    s_waitcnt lgkmcnt(10)
    v_mfma_f32_32x32x16_bf16 v[72:87], a[152:155], v[32:35], v[72:87]
    v_add_f32 v11, v11, v22
    v_add_f32 v12, v12, v23
    v_add_f32 v11, v11, v24
    v_add_f32 v12, v12, v25
    ds_read_b64_tr_b16 a[148:149], v242 offset:36864
    ds_read_b64_tr_b16 a[150:151], v243 offset:36864
    v_mfma_f32_32x32x16_bf16 v[88:103], a[156:159], v[32:35], v[88:103]
    v_add_f32 v11, v11, v26
    v_add_f32 v12, v12, v27
    v_add_f32 v11, v11, v28
    v_add_f32 v12, v12, v29
    ds_read_b64_tr_b16 a[152:153], v244 offset:36864
    ds_read_b64_tr_b16 a[154:155], v245 offset:36864
    s_waitcnt lgkmcnt(10)
    v_mfma_f32_32x32x16_bf16 v[104:119], a[128:131], v[32:35], v[104:119]
    v_add_f32 v11, v11, v30
    v_add_f32 v12, v12, v31
    v_add_f32 v11, v11, v12
    v_add_f32 v7, v7, v11
    ds_read_b64_tr_b16 a[156:157], v246 offset:36864
    ds_read_b64_tr_b16 a[158:159], v247 offset:36864
    v_mfma_f32_32x32x16_bf16 v[120:135], a[132:135], v[32:35], v[120:135]
    ds_read_b64_tr_b16 a[128:129], v240 offset:4096
    ds_read_b64_tr_b16 a[130:131], v241 offset:4096
    s_waitcnt lgkmcnt(10)
    v_mfma_f32_32x32x16_bf16 v[136:151], a[136:139], v[32:35], v[136:151]
    ds_read_b64_tr_b16 a[132:133], v242 offset:4096
    ds_read_b64_tr_b16 a[134:135], v243 offset:4096
    v_mfma_f32_32x32x16_bf16 v[152:167], a[140:143], v[32:35], v[152:167]
    ds_read_b64_tr_b16 a[136:137], v244 offset:4096
    ds_read_b64_tr_b16 a[138:139], v245 offset:4096
    s_waitcnt lgkmcnt(10)
    v_mfma_f32_32x32x16_bf16 v[168:183], a[144:147], v[36:39], v[168:183]
    ds_read_b64_tr_b16 a[140:141], v246 offset:4096
    ds_read_b64_tr_b16 a[142:143], v247 offset:4096
    v_mfma_f32_32x32x16_bf16 v[184:199], a[148:151], v[36:39], v[184:199]
    ds_read_b64_tr_b16 a[144:145], v240 offset:12288
    ds_read_b64_tr_b16 a[146:147], v241 offset:12288
    s_waitcnt lgkmcnt(10)
    v_mfma_f32_32x32x16_bf16 v[200:215], a[152:155], v[36:39], v[200:215]
    ds_read_b64_tr_b16 a[148:149], v242 offset:12288
    ds_read_b64_tr_b16 a[150:151], v243 offset:12288
    v_mfma_f32_32x32x16_bf16 v[216:231], a[156:159], v[36:39], v[216:231]
    ds_read_b64_tr_b16 a[152:153], v244 offset:12288
    s_add_u32 m0, s19, 32768
    s_add_u32 s27, s22, 311296
    buffer_load_dwordx4 v1, s[12:15], s27 offen offset:0 lds
    ds_read_b64_tr_b16 a[154:155], v245 offset:12288
    s_waitcnt lgkmcnt(10)
    v_mfma_f32_32x32x16_bf16 v[40:55], a[128:131], v[36:39], v[40:55]
    buffer_load_dwordx4 v1, s[12:15], s27 offen offset:1024 lds
    ds_read_b64_tr_b16 a[156:157], v246 offset:12288
    ds_read_b64_tr_b16 a[158:159], v247 offset:12288
    v_mfma_f32_32x32x16_bf16 v[56:71], a[132:135], v[36:39], v[56:71]
    buffer_load_dwordx4 v1, s[12:15], s27 offen offset:2048 lds
    s_waitcnt lgkmcnt(8)
    v_mfma_f32_32x32x16_bf16 v[72:87], a[136:139], v[36:39], v[72:87]
    buffer_load_dwordx4 v1, s[12:15], s27 offen offset:3072 lds
    v_mfma_f32_32x32x16_bf16 v[88:103], a[140:143], v[36:39], v[88:103]
    s_add_u32 m0, s19, 36864
    s_add_u32 s27, s22, 315392
    buffer_load_dwordx4 v1, s[12:15], s27 offen offset:0 lds
    s_waitcnt lgkmcnt(4)
    v_mfma_f32_32x32x16_bf16 v[104:119], a[144:147], v[36:39], v[104:119]
    buffer_load_dwordx4 v1, s[12:15], s27 offen offset:1024 lds
    s_waitcnt vmcnt(12)
    ds_read_b128 a[96:99], v232 offset:16384
    ds_read_b128 a[100:103], v233 offset:16384
    ds_read_b128 a[104:107], v234 offset:16384
    ds_read_b128 a[108:111], v235 offset:16384
    ds_read_b128 a[112:115], v236 offset:16384
    ds_read_b128 a[116:119], v237 offset:16384
    v_mfma_f32_32x32x16_bf16 v[120:135], a[148:151], v[36:39], v[120:135]
    buffer_load_dwordx4 v1, s[12:15], s27 offen offset:2048 lds
    s_waitcnt lgkmcnt(6)
    v_mfma_f32_32x32x16_bf16 v[136:151], a[152:155], v[36:39], v[136:151]
    buffer_load_dwordx4 v1, s[12:15], s27 offen offset:3072 lds
    v_mfma_f32_32x32x16_bf16 v[152:167], a[156:159], v[36:39], v[152:167]
    ds_read_b128 a[120:123], v238 offset:16384
    s_add_u32 m0, s19, 0
    s_add_u32 s27, s22, 393216
    buffer_load_dwordx4 v1, s[12:15], s27 offen offset:0 lds
    s_waitcnt lgkmcnt(5)
    v_mfma_f32_32x32x16_bf16 v[16:31], a[96:99], a[0:3], 0
    ds_read_b128 a[124:127], v239 offset:16384
    v_mfma_f32_32x32x16_bf16 v[16:31], a[100:103], a[4:7], v[16:31]
    buffer_load_dwordx4 v1, s[12:15], s27 offen offset:1024 lds
    ds_read_b128 a[96:99], v232 offset:24576
    s_waitcnt lgkmcnt(5)
    v_mfma_f32_32x32x16_bf16 v[16:31], a[104:107], a[8:11], v[16:31]
    ds_read_b128 a[100:103], v233 offset:24576
    v_mfma_f32_32x32x16_bf16 v[16:31], a[108:111], a[12:15], v[16:31]
    buffer_load_dwordx4 v1, s[12:15], s27 offen offset:2048 lds
    ds_read_b128 a[104:107], v234 offset:24576
    s_waitcnt lgkmcnt(5)
    v_mfma_f32_32x32x16_bf16 v[16:31], a[112:115], a[16:19], v[16:31]
    ds_read_b128 a[108:111], v235 offset:24576
    v_mfma_f32_32x32x16_bf16 v[16:31], a[116:119], a[20:23], v[16:31]
    buffer_load_dwordx4 v1, s[12:15], s27 offen offset:3072 lds
    ds_read_b128 a[112:115], v236 offset:24576
    s_waitcnt lgkmcnt(5)
    v_mfma_f32_32x32x16_bf16 v[16:31], a[120:123], a[24:27], v[16:31]
    ds_read_b128 a[116:119], v237 offset:24576
    v_mfma_f32_32x32x16_bf16 v[16:31], a[124:127], a[28:31], v[16:31]
    s_add_u32 m0, s19, 4096
    s_add_u32 s27, s22, 397312
    buffer_load_dwordx4 v1, s[12:15], s27 offen offset:0 lds
    ds_read_b128 a[120:123], v238 offset:24576
    s_waitcnt lgkmcnt(5)
    v_mfma_f32_32x32x16_bf16 v[16:31], a[96:99], a[32:35], v[16:31]
    ds_read_b128 a[124:127], v239 offset:24576
    v_mfma_f32_32x32x16_bf16 v[16:31], a[100:103], a[36:39], v[16:31]
    buffer_load_dwordx4 v1, s[12:15], s27 offen offset:1024 lds
    s_waitcnt vmcnt(6)
    ds_read_b128 a[96:99], v232 offset:32768
    s_waitcnt lgkmcnt(5)
    v_mfma_f32_32x32x16_bf16 v[16:31], a[104:107], a[40:43], v[16:31]
    ds_read_b128 a[100:103], v233 offset:32768
    v_mfma_f32_32x32x16_bf16 v[16:31], a[108:111], a[44:47], v[16:31]
    buffer_load_dwordx4 v1, s[12:15], s27 offen offset:2048 lds
    ds_read_b128 a[104:107], v234 offset:32768
    s_waitcnt lgkmcnt(5)
    v_mfma_f32_32x32x16_bf16 v[16:31], a[112:115], a[48:51], v[16:31]
    ds_read_b128 a[108:111], v235 offset:32768
    v_mfma_f32_32x32x16_bf16 v[16:31], a[116:119], a[52:55], v[16:31]
    buffer_load_dwordx4 v1, s[12:15], s27 offen offset:3072 lds
    ds_read_b128 a[112:115], v236 offset:32768
    s_waitcnt lgkmcnt(5)
    v_mfma_f32_32x32x16_bf16 v[16:31], a[120:123], a[56:59], v[16:31]
    ds_read_b128 a[116:119], v237 offset:32768
    v_mfma_f32_32x32x16_bf16 v[16:31], a[124:127], a[60:63], v[16:31]
    s_add_u32 m0, s19, 8192
    s_add_u32 s27, s22, 401408
    buffer_load_dwordx4 v1, s[12:15], s27 offen offset:0 lds
    ds_read_b128 a[120:123], v238 offset:32768
    s_waitcnt lgkmcnt(5)
    v_mfma_f32_32x32x16_bf16 v[16:31], a[96:99], a[64:67], v[16:31]
    ds_read_b128 a[124:127], v239 offset:32768
    v_mfma_f32_32x32x16_bf16 v[16:31], a[100:103], a[68:71], v[16:31]
    buffer_load_dwordx4 v1, s[12:15], s27 offen offset:1024 lds
    s_waitcnt lgkmcnt(4)
    v_mfma_f32_32x32x16_bf16 v[16:31], a[104:107], a[72:75], v[16:31]
    v_mfma_f32_32x32x16_bf16 v[16:31], a[108:111], a[76:79], v[16:31]
    buffer_load_dwordx4 v1, s[12:15], s27 offen offset:2048 lds
    s_waitcnt lgkmcnt(2)
    v_mfma_f32_32x32x16_bf16 v[16:31], a[112:115], a[80:83], v[16:31]
    v_mfma_f32_32x32x16_bf16 v[16:31], a[116:119], a[84:87], v[16:31]
    buffer_load_dwordx4 v1, s[12:15], s27 offen offset:3072 lds
    s_waitcnt lgkmcnt(0)
    v_mfma_f32_32x32x16_bf16 v[16:31], a[120:123], a[88:91], v[16:31]
    v_mfma_f32_32x32x16_bf16 v[16:31], a[124:127], a[92:95], v[16:31]
    s_add_u32 m0, s19, 12288
    s_add_u32 s27, s22, 405504
    buffer_load_dwordx4 v1, s[12:15], s27 offen offset:0 lds
    ds_read_b64_tr_b16 a[128:129], v240 offset:32768
    ds_read_b64_tr_b16 a[130:131], v241 offset:32768
    ds_read_b64_tr_b16 a[132:133], v242 offset:32768
    ds_read_b64_tr_b16 a[134:135], v243 offset:32768
    ds_read_b64_tr_b16 a[136:137], v244 offset:32768
    ds_read_b64_tr_b16 a[138:139], v245 offset:32768
    ds_read_b64_tr_b16 a[140:141], v246 offset:32768
    ds_read_b64_tr_b16 a[142:143], v247 offset:32768
    ds_read_b64_tr_b16 a[144:145], v240 offset:16384
    ds_read_b64_tr_b16 a[146:147], v241 offset:16384
    ds_read_b64_tr_b16 a[148:149], v242 offset:16384
    ds_read_b64_tr_b16 a[150:151], v243 offset:16384
    v_max3_f32 v11, v16, v17, v18
    v_max3_f32 v12, v19, v20, v21
    v_max3_f32 v11, v11, v22, v23
    buffer_load_dwordx4 v1, s[12:15], s27 offen offset:1024 lds
    v_max3_f32 v12, v12, v24, v25
    v_max3_f32 v11, v11, v26, v27
    v_max3_f32 v12, v12, v28, v29
    v_max3_f32 v11, v11, v30, v31
    v_max_f32 v11, v11, v12
    v_mov_b32 v12, v11
    s_nop 1
    v_permlane32_swap_b32 v11, v12
    v_max_f32 v11, v11, v12
    v_sub_f32 v12, v11, v6
    v_cmp_lt_f32 vcc, s24, v12
    s_nop 1
    s_cbranch_vccz K2_NORESC_3
    v_max_f32 v11, v11, v6
    v_sub_f32 v12, v6, v11
    v_exp_f32 v12, v12
    v_mov_b32 v6, v11
    v_mul_f32 v7, v7, v12
    v_mul_f32 v40, v40, v12
    v_mul_f32 v41, v41, v12
    v_mul_f32 v42, v42, v12
    v_mul_f32 v43, v43, v12
    v_mul_f32 v44, v44, v12
    v_mul_f32 v45, v45, v12
    v_mul_f32 v46, v46, v12
    v_mul_f32 v47, v47, v12
    v_mul_f32 v48, v48, v12
    v_mul_f32 v49, v49, v12
    v_mul_f32 v50, v50, v12
    v_mul_f32 v51, v51, v12
    v_mul_f32 v52, v52, v12
    v_mul_f32 v53, v53, v12
    v_mul_f32 v54, v54, v12
    v_mul_f32 v55, v55, v12
    v_mul_f32 v56, v56, v12
    v_mul_f32 v57, v57, v12
    v_mul_f32 v58, v58, v12
    v_mul_f32 v59, v59, v12
    v_mul_f32 v60, v60, v12
    v_mul_f32 v61, v61, v12
    v_mul_f32 v62, v62, v12
    v_mul_f32 v63, v63, v12
    v_mul_f32 v64, v64, v12
    v_mul_f32 v65, v65, v12
    v_mul_f32 v66, v66, v12
    v_mul_f32 v67, v67, v12
    v_mul_f32 v68, v68, v12
    v_mul_f32 v69, v69, v12
    v_mul_f32 v70, v70, v12
    v_mul_f32 v71, v71, v12
    v_mul_f32 v72, v72, v12
    v_mul_f32 v73, v73, v12
    v_mul_f32 v74, v74, v12
    v_mul_f32 v75, v75, v12
    v_mul_f32 v76, v76, v12
    v_mul_f32 v77, v77, v12
    v_mul_f32 v78, v78, v12
    v_mul_f32 v79, v79, v12
    v_mul_f32 v80, v80, v12
    v_mul_f32 v81, v81, v12
    v_mul_f32 v82, v82, v12
    v_mul_f32 v83, v83, v12
    v_mul_f32 v84, v84, v12
    v_mul_f32 v85, v85, v12
    v_mul_f32 v86, v86, v12
    v_mul_f32 v87, v87, v12
    v_mul_f32 v88, v88, v12
    v_mul_f32 v89, v89, v12
    v_mul_f32 v90, v90, v12
    v_mul_f32 v91, v91, v12
    v_mul_f32 v92, v92, v12
    v_mul_f32 v93, v93, v12
    v_mul_f32 v94, v94, v12
    v_mul_f32 v95, v95, v12
    v_mul_f32 v96, v96, v12
    v_mul_f32 v97, v97, v12
    v_mul_f32 v98, v98, v12
    v_mul_f32 v99, v99, v12
    v_mul_f32 v100, v100, v12
    v_mul_f32 v101, v101, v12
    v_mul_f32 v102, v102, v12
    v_mul_f32 v103, v103, v12
    v_mul_f32 v104, v104, v12
    v_mul_f32 v105, v105, v12
    v_mul_f32 v106, v106, v12
    v_mul_f32 v107, v107, v12
    v_mul_f32 v108, v108, v12
    v_mul_f32 v109, v109, v12
    v_mul_f32 v110, v110, v12
    v_mul_f32 v111, v111, v12
    v_mul_f32 v112, v112, v12
    v_mul_f32 v113, v113, v12
    v_mul_f32 v114, v114, v12
    v_mul_f32 v115, v115, v12
    v_mul_f32 v116, v116, v12
    v_mul_f32 v117, v117, v12
    v_mul_f32 v118, v118, v12
    v_mul_f32 v119, v119, v12
    v_mul_f32 v120, v120, v12
    v_mul_f32 v121, v121, v12
    v_mul_f32 v122, v122, v12
    v_mul_f32 v123, v123, v12
    v_mul_f32 v124, v124, v12
    v_mul_f32 v125, v125, v12
    v_mul_f32 v126, v126, v12
    v_mul_f32 v127, v127, v12
    v_mul_f32 v128, v128, v12
    v_mul_f32 v129, v129, v12
    v_mul_f32 v130, v130, v12
    v_mul_f32 v131, v131, v12
    v_mul_f32 v132, v132, v12
    v_mul_f32 v133, v133, v12
    v_mul_f32 v134, v134, v12
    v_mul_f32 v135, v135, v12
    v_mul_f32 v136, v136, v12
    v_mul_f32 v137, v137, v12
    v_mul_f32 v138, v138, v12
    v_mul_f32 v139, v139, v12
    v_mul_f32 v140, v140, v12
    v_mul_f32 v141, v141, v12
    v_mul_f32 v142, v142, v12
    v_mul_f32 v143, v143, v12
    v_mul_f32 v144, v144, v12
    v_mul_f32 v145, v145, v12
    v_mul_f32 v146, v146, v12
    v_mul_f32 v147, v147, v12
    v_mul_f32 v148, v148, v12
    v_mul_f32 v149, v149, v12
    v_mul_f32 v150, v150, v12
    v_mul_f32 v151, v151, v12
    v_mul_f32 v152, v152, v12
    v_mul_f32 v153, v153, v12
    v_mul_f32 v154, v154, v12
    v_mul_f32 v155, v155, v12
    v_mul_f32 v156, v156, v12
    v_mul_f32 v157, v157, v12
    v_mul_f32 v158, v158, v12
    v_mul_f32 v159, v159, v12
    v_mul_f32 v160, v160, v12
    v_mul_f32 v161, v161, v12
    v_mul_f32 v162, v162, v12
    v_mul_f32 v163, v163, v12
    v_mul_f32 v164, v164, v12
    v_mul_f32 v165, v165, v12
    v_mul_f32 v166, v166, v12
    v_mul_f32 v167, v167, v12
    v_mul_f32 v168, v168, v12
    v_mul_f32 v169, v169, v12
    v_mul_f32 v170, v170, v12
    v_mul_f32 v171, v171, v12
    v_mul_f32 v172, v172, v12
    v_mul_f32 v173, v173, v12
    v_mul_f32 v174, v174, v12
    v_mul_f32 v175, v175, v12
    v_mul_f32 v176, v176, v12
    v_mul_f32 v177, v177, v12
    v_mul_f32 v178, v178, v12
    v_mul_f32 v179, v179, v12
    v_mul_f32 v180, v180, v12
    v_mul_f32 v181, v181, v12
    v_mul_f32 v182, v182, v12
    v_mul_f32 v183, v183, v12
    v_mul_f32 v184, v184, v12
    v_mul_f32 v185, v185, v12
    v_mul_f32 v186, v186, v12
    v_mul_f32 v187, v187, v12
    v_mul_f32 v188, v188, v12
    v_mul_f32 v189, v189, v12
    v_mul_f32 v190, v190, v12
    v_mul_f32 v191, v191, v12
    v_mul_f32 v192, v192, v12
    v_mul_f32 v193, v193, v12
    v_mul_f32 v194, v194, v12
    v_mul_f32 v195, v195, v12
    v_mul_f32 v196, v196, v12
    v_mul_f32 v197, v197, v12
    v_mul_f32 v198, v198, v12
    v_mul_f32 v199, v199, v12
    v_mul_f32 v200, v200, v12
    v_mul_f32 v201, v201, v12
    v_mul_f32 v202, v202, v12
    v_mul_f32 v203, v203, v12
    v_mul_f32 v204, v204, v12
    v_mul_f32 v205, v205, v12
    v_mul_f32 v206, v206, v12
    v_mul_f32 v207, v207, v12
    v_mul_f32 v208, v208, v12
    v_mul_f32 v209, v209, v12
    v_mul_f32 v210, v210, v12
    v_mul_f32 v211, v211, v12
    v_mul_f32 v212, v212, v12
    v_mul_f32 v213, v213, v12
    v_mul_f32 v214, v214, v12
    v_mul_f32 v215, v215, v12
    v_mul_f32 v216, v216, v12
    v_mul_f32 v217, v217, v12
    v_mul_f32 v218, v218, v12
    v_mul_f32 v219, v219, v12
    v_mul_f32 v220, v220, v12
    v_mul_f32 v221, v221, v12
    v_mul_f32 v222, v222, v12
    v_mul_f32 v223, v223, v12
    v_mul_f32 v224, v224, v12
    v_mul_f32 v225, v225, v12
    v_mul_f32 v226, v226, v12
    v_mul_f32 v227, v227, v12
    v_mul_f32 v228, v228, v12
    v_mul_f32 v229, v229, v12
    v_mul_f32 v230, v230, v12
    v_mul_f32 v231, v231, v12
    s_nop 3
K2_NORESC_3:
    v_sub_f32 v16, v16, v6
    buffer_load_dwordx4 v1, s[12:15], s27 offen offset:2048 lds
    v_sub_f32 v17, v17, v6
    v_sub_f32 v18, v18, v6
    v_sub_f32 v19, v19, v6
    v_sub_f32 v20, v20, v6
    v_sub_f32 v21, v21, v6
    v_sub_f32 v22, v22, v6
    v_sub_f32 v23, v23, v6
    v_exp_f32 v16, v16
    v_exp_f32 v17, v17
    v_exp_f32 v18, v18
    v_exp_f32 v19, v19
    buffer_load_dwordx4 v1, s[12:15], s27 offen offset:3072 lds
    v_exp_f32 v20, v20
    v_exp_f32 v21, v21
    v_exp_f32 v22, v22
    v_exp_f32 v23, v23
    v_cvt_pk_bf16_f32 v32, v16, v17
    v_cvt_pk_bf16_f32 v33, v18, v19
    v_cvt_pk_bf16_f32 v34, v20, v21
    v_cvt_pk_bf16_f32 v35, v22, v23
    ds_read_b64_tr_b16 a[152:153], v244 offset:16384
    ds_read_b64_tr_b16 a[154:155], v245 offset:16384
    s_waitcnt lgkmcnt(10)
    s_add_u32 s29, s28, 897024
    buffer_load_dwordx4 a[208:211], v1, s[12:15], s29 offen
    v_mfma_f32_32x32x16_bf16 v[168:183], a[128:131], v[32:35], v[168:183]
    v_sub_f32 v24, v24, v6
    v_sub_f32 v25, v25, v6
    v_sub_f32 v26, v26, v6
    v_sub_f32 v27, v27, v6
    ds_read_b64_tr_b16 a[156:157], v246 offset:16384
    ds_read_b64_tr_b16 a[158:159], v247 offset:16384
    v_mfma_f32_32x32x16_bf16 v[184:199], a[132:135], v[32:35], v[184:199]
    s_add_u32 s29, s28, 898048
    buffer_load_dwordx4 a[212:215], v1, s[12:15], s29 offen
    v_sub_f32 v28, v28, v6
    v_sub_f32 v29, v29, v6
    v_sub_f32 v30, v30, v6
    v_sub_f32 v31, v31, v6
    ds_read_b64_tr_b16 a[128:129], v240 offset:24576
    ds_read_b64_tr_b16 a[130:131], v241 offset:24576
    s_waitcnt lgkmcnt(10)
    v_mfma_f32_32x32x16_bf16 v[200:215], a[136:139], v[32:35], v[200:215]
    s_add_u32 s29, s28, 899072
    buffer_load_dwordx4 a[216:219], v1, s[12:15], s29 offen
    v_exp_f32 v24, v24
    v_exp_f32 v25, v25
    v_exp_f32 v26, v26
    v_exp_f32 v27, v27
    ds_read_b64_tr_b16 a[132:133], v242 offset:24576
    ds_read_b64_tr_b16 a[134:135], v243 offset:24576
    v_mfma_f32_32x32x16_bf16 v[216:231], a[140:143], v[32:35], v[216:231]
    s_add_u32 s29, s28, 900096
    buffer_load_dwordx4 a[220:223], v1, s[12:15], s29 offen
    v_exp_f32 v28, v28
    v_exp_f32 v29, v29
    v_exp_f32 v30, v30
    v_exp_f32 v31, v31
    ds_read_b64_tr_b16 a[136:137], v244 offset:24576
    ds_read_b64_tr_b16 a[138:139], v245 offset:24576
    s_waitcnt lgkmcnt(10)
    v_mfma_f32_32x32x16_bf16 v[40:55], a[144:147], v[32:35], v[40:55]
    s_add_u32 s29, s28, 901120
    buffer_load_dwordx4 a[224:227], v1, s[12:15], s29 offen
    v_cvt_pk_bf16_f32 v36, v24, v25
    v_cvt_pk_bf16_f32 v37, v26, v27
    v_cvt_pk_bf16_f32 v38, v28, v29
    v_cvt_pk_bf16_f32 v39, v30, v31
    ds_read_b64_tr_b16 a[140:141], v246 offset:24576
    ds_read_b64_tr_b16 a[142:143], v247 offset:24576
    v_mfma_f32_32x32x16_bf16 v[56:71], a[148:151], v[32:35], v[56:71]
    v_add_f32 v11, v16, v17
    s_add_u32 s29, s28, 902144
    buffer_load_dwordx4 a[228:231], v1, s[12:15], s29 offen
    v_add_f32 v12, v18, v19
    v_add_f32 v11, v11, v20
    v_add_f32 v12, v12, v21
    ds_read_b64_tr_b16 a[144:145], v240 offset:36864
    ds_read_b64_tr_b16 a[146:147], v241 offset:36864
    s_waitcnt lgkmcnt(10)
    v_mfma_f32_32x32x16_bf16 v[72:87], a[152:155], v[32:35], v[72:87]
    v_add_f32 v11, v11, v22
    v_add_f32 v12, v12, v23
    v_add_f32 v11, v11, v24
    v_add_f32 v12, v12, v25
    ds_read_b64_tr_b16 a[148:149], v242 offset:36864
    ds_read_b64_tr_b16 a[150:151], v243 offset:36864
    v_mfma_f32_32x32x16_bf16 v[88:103], a[156:159], v[32:35], v[88:103]
    v_add_f32 v11, v11, v26
    v_add_f32 v12, v12, v27
    v_add_f32 v11, v11, v28
    v_add_f32 v12, v12, v29
    ds_read_b64_tr_b16 a[152:153], v244 offset:36864
    ds_read_b64_tr_b16 a[154:155], v245 offset:36864
    s_waitcnt lgkmcnt(10)
    v_mfma_f32_32x32x16_bf16 v[104:119], a[128:131], v[32:35], v[104:119]
    v_add_f32 v11, v11, v30
    v_add_f32 v12, v12, v31
    v_add_f32 v11, v11, v12
    v_add_f32 v7, v7, v11
    ds_read_b64_tr_b16 a[156:157], v246 offset:36864
    ds_read_b64_tr_b16 a[158:159], v247 offset:36864
    v_mfma_f32_32x32x16_bf16 v[120:135], a[132:135], v[32:35], v[120:135]
    ds_read_b64_tr_b16 a[128:129], v240 offset:20480
    ds_read_b64_tr_b16 a[130:131], v241 offset:20480
    s_waitcnt lgkmcnt(10)
    v_mfma_f32_32x32x16_bf16 v[136:151], a[136:139], v[32:35], v[136:151]
    ds_read_b64_tr_b16 a[132:133], v242 offset:20480
    ds_read_b64_tr_b16 a[134:135], v243 offset:20480
    v_mfma_f32_32x32x16_bf16 v[152:167], a[140:143], v[32:35], v[152:167]
    ds_read_b64_tr_b16 a[136:137], v244 offset:20480
    ds_read_b64_tr_b16 a[138:139], v245 offset:20480
    s_waitcnt lgkmcnt(10)
    v_mfma_f32_32x32x16_bf16 v[168:183], a[144:147], v[36:39], v[168:183]
    ds_read_b64_tr_b16 a[140:141], v246 offset:20480
    ds_read_b64_tr_b16 a[142:143], v247 offset:20480
    v_mfma_f32_32x32x16_bf16 v[184:199], a[148:151], v[36:39], v[184:199]
    ds_read_b64_tr_b16 a[144:145], v240 offset:28672
    ds_read_b64_tr_b16 a[146:147], v241 offset:28672
    s_waitcnt lgkmcnt(10)
    v_mfma_f32_32x32x16_bf16 v[200:215], a[152:155], v[36:39], v[200:215]
    ds_read_b64_tr_b16 a[148:149], v242 offset:28672
    ds_read_b64_tr_b16 a[150:151], v243 offset:28672
    v_mfma_f32_32x32x16_bf16 v[216:231], a[156:159], v[36:39], v[216:231]
    ds_read_b64_tr_b16 a[152:153], v244 offset:28672
    s_add_u32 m0, s19, 32768
    s_add_u32 s27, s22, 409600
    buffer_load_dwordx4 v1, s[12:15], s27 offen offset:0 lds
    ds_read_b64_tr_b16 a[154:155], v245 offset:28672
    s_waitcnt lgkmcnt(10)
    v_mfma_f32_32x32x16_bf16 v[40:55], a[128:131], v[36:39], v[40:55]
    buffer_load_dwordx4 v1, s[12:15], s27 offen offset:1024 lds
    ds_read_b64_tr_b16 a[156:157], v246 offset:28672
    ds_read_b64_tr_b16 a[158:159], v247 offset:28672
    v_mfma_f32_32x32x16_bf16 v[56:71], a[132:135], v[36:39], v[56:71]
    buffer_load_dwordx4 v1, s[12:15], s27 offen offset:2048 lds
    s_waitcnt lgkmcnt(8)
    v_mfma_f32_32x32x16_bf16 v[72:87], a[136:139], v[36:39], v[72:87]
    buffer_load_dwordx4 v1, s[12:15], s27 offen offset:3072 lds
    v_mfma_f32_32x32x16_bf16 v[88:103], a[140:143], v[36:39], v[88:103]
    s_add_u32 m0, s19, 36864
    s_add_u32 s27, s22, 413696
    buffer_load_dwordx4 v1, s[12:15], s27 offen offset:0 lds
    s_waitcnt lgkmcnt(4)
    v_mfma_f32_32x32x16_bf16 v[104:119], a[144:147], v[36:39], v[104:119]
    buffer_load_dwordx4 v1, s[12:15], s27 offen offset:1024 lds
    s_waitcnt vmcnt(12)
    ds_read_b128 a[96:99], v232 offset:0
    ds_read_b128 a[100:103], v233 offset:0
    ds_read_b128 a[104:107], v234 offset:0
    ds_read_b128 a[108:111], v235 offset:0
    ds_read_b128 a[112:115], v236 offset:0
    ds_read_b128 a[116:119], v237 offset:0
    v_mfma_f32_32x32x16_bf16 v[120:135], a[148:151], v[36:39], v[120:135]
    buffer_load_dwordx4 v1, s[12:15], s27 offen offset:2048 lds
    s_waitcnt lgkmcnt(6)
    v_mfma_f32_32x32x16_bf16 v[136:151], a[152:155], v[36:39], v[136:151]
    buffer_load_dwordx4 v1, s[12:15], s27 offen offset:3072 lds
    v_mfma_f32_32x32x16_bf16 v[152:167], a[156:159], v[36:39], v[152:167]
    ds_read_b128 a[120:123], v238 offset:0
    s_add_u32 m0, s19, 16384
    s_add_u32 s27, s22, 491520
    buffer_load_dwordx4 v1, s[12:15], s27 offen offset:0 lds
    s_waitcnt lgkmcnt(5)
    v_mfma_f32_32x32x16_bf16 v[16:31], a[96:99], a[0:3], 0
    ds_read_b128 a[124:127], v239 offset:0
    v_mfma_f32_32x32x16_bf16 v[16:31], a[100:103], a[4:7], v[16:31]
    buffer_load_dwordx4 v1, s[12:15], s27 offen offset:1024 lds
    ds_read_b128 a[96:99], v232 offset:8192
    s_waitcnt lgkmcnt(5)
    v_mfma_f32_32x32x16_bf16 v[16:31], a[104:107], a[8:11], v[16:31]
    ds_read_b128 a[100:103], v233 offset:8192
    v_mfma_f32_32x32x16_bf16 v[16:31], a[108:111], a[12:15], v[16:31]
    buffer_load_dwordx4 v1, s[12:15], s27 offen offset:2048 lds
    ds_read_b128 a[104:107], v234 offset:8192
    s_waitcnt lgkmcnt(5)
    v_mfma_f32_32x32x16_bf16 v[16:31], a[112:115], a[16:19], v[16:31]
    ds_read_b128 a[108:111], v235 offset:8192
    v_mfma_f32_32x32x16_bf16 v[16:31], a[116:119], a[20:23], v[16:31]
    buffer_load_dwordx4 v1, s[12:15], s27 offen offset:3072 lds
    ds_read_b128 a[112:115], v236 offset:8192
    s_waitcnt lgkmcnt(5)
    v_mfma_f32_32x32x16_bf16 v[16:31], a[120:123], a[24:27], v[16:31]
    ds_read_b128 a[116:119], v237 offset:8192
    v_mfma_f32_32x32x16_bf16 v[16:31], a[124:127], a[28:31], v[16:31]
    s_add_u32 m0, s19, 20480
    s_add_u32 s27, s22, 495616
    buffer_load_dwordx4 v1, s[12:15], s27 offen offset:0 lds
    ds_read_b128 a[120:123], v238 offset:8192
    s_waitcnt lgkmcnt(5)
    v_mfma_f32_32x32x16_bf16 v[16:31], a[96:99], a[32:35], v[16:31]
    ds_read_b128 a[124:127], v239 offset:8192
    v_mfma_f32_32x32x16_bf16 v[16:31], a[100:103], a[36:39], v[16:31]
    buffer_load_dwordx4 v1, s[12:15], s27 offen offset:1024 lds
    s_waitcnt vmcnt(6)
    ds_read_b128 a[96:99], v232 offset:32768
    s_waitcnt lgkmcnt(5)
    v_mfma_f32_32x32x16_bf16 v[16:31], a[104:107], a[40:43], v[16:31]
    ds_read_b128 a[100:103], v233 offset:32768
    v_mfma_f32_32x32x16_bf16 v[16:31], a[108:111], a[44:47], v[16:31]
    buffer_load_dwordx4 v1, s[12:15], s27 offen offset:2048 lds
    ds_read_b128 a[104:107], v234 offset:32768
    s_waitcnt lgkmcnt(5)
    v_mfma_f32_32x32x16_bf16 v[16:31], a[112:115], a[48:51], v[16:31]
    ds_read_b128 a[108:111], v235 offset:32768
    v_mfma_f32_32x32x16_bf16 v[16:31], a[116:119], a[52:55], v[16:31]
    buffer_load_dwordx4 v1, s[12:15], s27 offen offset:3072 lds
    ds_read_b128 a[112:115], v236 offset:32768
    s_waitcnt lgkmcnt(5)
    v_mfma_f32_32x32x16_bf16 v[16:31], a[120:123], a[56:59], v[16:31]
    ds_read_b128 a[116:119], v237 offset:32768
    v_mfma_f32_32x32x16_bf16 v[16:31], a[124:127], a[60:63], v[16:31]
    s_add_u32 m0, s19, 24576
    s_add_u32 s27, s22, 499712
    buffer_load_dwordx4 v1, s[12:15], s27 offen offset:0 lds
    ds_read_b128 a[120:123], v238 offset:32768
    s_waitcnt lgkmcnt(5)
    v_mfma_f32_32x32x16_bf16 v[16:31], a[96:99], a[64:67], v[16:31]
    ds_read_b128 a[124:127], v239 offset:32768
    v_mfma_f32_32x32x16_bf16 v[16:31], a[100:103], a[68:71], v[16:31]
    buffer_load_dwordx4 v1, s[12:15], s27 offen offset:1024 lds
    s_waitcnt lgkmcnt(4)
    v_mfma_f32_32x32x16_bf16 v[16:31], a[104:107], a[72:75], v[16:31]
    v_mfma_f32_32x32x16_bf16 v[16:31], a[108:111], a[76:79], v[16:31]
    buffer_load_dwordx4 v1, s[12:15], s27 offen offset:2048 lds
    s_waitcnt lgkmcnt(2)
    v_mfma_f32_32x32x16_bf16 v[16:31], a[112:115], a[80:83], v[16:31]
    v_mfma_f32_32x32x16_bf16 v[16:31], a[116:119], a[84:87], v[16:31]
    buffer_load_dwordx4 v1, s[12:15], s27 offen offset:3072 lds
    s_waitcnt lgkmcnt(0)
    v_mfma_f32_32x32x16_bf16 v[16:31], a[120:123], a[88:91], v[16:31]
    v_mfma_f32_32x32x16_bf16 v[16:31], a[124:127], a[92:95], v[16:31]
    s_add_u32 m0, s19, 28672
    s_add_u32 s27, s22, 503808
    buffer_load_dwordx4 v1, s[12:15], s27 offen offset:0 lds
    ds_read_b64_tr_b16 a[128:129], v240 offset:32768
    ds_read_b64_tr_b16 a[130:131], v241 offset:32768
    ds_read_b64_tr_b16 a[132:133], v242 offset:32768
    ds_read_b64_tr_b16 a[134:135], v243 offset:32768
    ds_read_b64_tr_b16 a[136:137], v244 offset:32768
    ds_read_b64_tr_b16 a[138:139], v245 offset:32768
    ds_read_b64_tr_b16 a[140:141], v246 offset:32768
    ds_read_b64_tr_b16 a[142:143], v247 offset:32768
    ds_read_b64_tr_b16 a[144:145], v240 offset:0
    ds_read_b64_tr_b16 a[146:147], v241 offset:0
    ds_read_b64_tr_b16 a[148:149], v242 offset:0
    ds_read_b64_tr_b16 a[150:151], v243 offset:0
    v_max3_f32 v11, v16, v17, v18
    v_max3_f32 v12, v19, v20, v21
    v_max3_f32 v11, v11, v22, v23
    buffer_load_dwordx4 v1, s[12:15], s27 offen offset:1024 lds
    v_max3_f32 v12, v12, v24, v25
    v_max3_f32 v11, v11, v26, v27
    v_max3_f32 v12, v12, v28, v29
    v_max3_f32 v11, v11, v30, v31
    v_max_f32 v11, v11, v12
    v_mov_b32 v12, v11
    s_nop 1
    v_permlane32_swap_b32 v11, v12
    v_max_f32 v11, v11, v12
    v_sub_f32 v12, v11, v6
    v_cmp_lt_f32 vcc, s24, v12
    s_nop 1
    s_cbranch_vccz K2_NORESC_4
    v_max_f32 v11, v11, v6
    v_sub_f32 v12, v6, v11
    v_exp_f32 v12, v12
    v_mov_b32 v6, v11
    v_mul_f32 v7, v7, v12
    v_mul_f32 v40, v40, v12
    v_mul_f32 v41, v41, v12
    v_mul_f32 v42, v42, v12
    v_mul_f32 v43, v43, v12
    v_mul_f32 v44, v44, v12
    v_mul_f32 v45, v45, v12
    v_mul_f32 v46, v46, v12
    v_mul_f32 v47, v47, v12
    v_mul_f32 v48, v48, v12
    v_mul_f32 v49, v49, v12
    v_mul_f32 v50, v50, v12
    v_mul_f32 v51, v51, v12
    v_mul_f32 v52, v52, v12
    v_mul_f32 v53, v53, v12
    v_mul_f32 v54, v54, v12
    v_mul_f32 v55, v55, v12
    v_mul_f32 v56, v56, v12
    v_mul_f32 v57, v57, v12
    v_mul_f32 v58, v58, v12
    v_mul_f32 v59, v59, v12
    v_mul_f32 v60, v60, v12
    v_mul_f32 v61, v61, v12
    v_mul_f32 v62, v62, v12
    v_mul_f32 v63, v63, v12
    v_mul_f32 v64, v64, v12
    v_mul_f32 v65, v65, v12
    v_mul_f32 v66, v66, v12
    v_mul_f32 v67, v67, v12
    v_mul_f32 v68, v68, v12
    v_mul_f32 v69, v69, v12
    v_mul_f32 v70, v70, v12
    v_mul_f32 v71, v71, v12
    v_mul_f32 v72, v72, v12
    v_mul_f32 v73, v73, v12
    v_mul_f32 v74, v74, v12
    v_mul_f32 v75, v75, v12
    v_mul_f32 v76, v76, v12
    v_mul_f32 v77, v77, v12
    v_mul_f32 v78, v78, v12
    v_mul_f32 v79, v79, v12
    v_mul_f32 v80, v80, v12
    v_mul_f32 v81, v81, v12
    v_mul_f32 v82, v82, v12
    v_mul_f32 v83, v83, v12
    v_mul_f32 v84, v84, v12
    v_mul_f32 v85, v85, v12
    v_mul_f32 v86, v86, v12
    v_mul_f32 v87, v87, v12
    v_mul_f32 v88, v88, v12
    v_mul_f32 v89, v89, v12
    v_mul_f32 v90, v90, v12
    v_mul_f32 v91, v91, v12
    v_mul_f32 v92, v92, v12
    v_mul_f32 v93, v93, v12
    v_mul_f32 v94, v94, v12
    v_mul_f32 v95, v95, v12
    v_mul_f32 v96, v96, v12
    v_mul_f32 v97, v97, v12
    v_mul_f32 v98, v98, v12
    v_mul_f32 v99, v99, v12
    v_mul_f32 v100, v100, v12
    v_mul_f32 v101, v101, v12
    v_mul_f32 v102, v102, v12
    v_mul_f32 v103, v103, v12
    v_mul_f32 v104, v104, v12
    v_mul_f32 v105, v105, v12
    v_mul_f32 v106, v106, v12
    v_mul_f32 v107, v107, v12
    v_mul_f32 v108, v108, v12
    v_mul_f32 v109, v109, v12
    v_mul_f32 v110, v110, v12
    v_mul_f32 v111, v111, v12
    v_mul_f32 v112, v112, v12
    v_mul_f32 v113, v113, v12
    v_mul_f32 v114, v114, v12
    v_mul_f32 v115, v115, v12
    v_mul_f32 v116, v116, v12
    v_mul_f32 v117, v117, v12
    v_mul_f32 v118, v118, v12
    v_mul_f32 v119, v119, v12
    v_mul_f32 v120, v120, v12
    v_mul_f32 v121, v121, v12
    v_mul_f32 v122, v122, v12
    v_mul_f32 v123, v123, v12
    v_mul_f32 v124, v124, v12
    v_mul_f32 v125, v125, v12
    v_mul_f32 v126, v126, v12
    v_mul_f32 v127, v127, v12
    v_mul_f32 v128, v128, v12
    v_mul_f32 v129, v129, v12
    v_mul_f32 v130, v130, v12
    v_mul_f32 v131, v131, v12
    v_mul_f32 v132, v132, v12
    v_mul_f32 v133, v133, v12
    v_mul_f32 v134, v134, v12
    v_mul_f32 v135, v135, v12
    v_mul_f32 v136, v136, v12
    v_mul_f32 v137, v137, v12
    v_mul_f32 v138, v138, v12
    v_mul_f32 v139, v139, v12
    v_mul_f32 v140, v140, v12
    v_mul_f32 v141, v141, v12
    v_mul_f32 v142, v142, v12
    v_mul_f32 v143, v143, v12
    v_mul_f32 v144, v144, v12
    v_mul_f32 v145, v145, v12
    v_mul_f32 v146, v146, v12
    v_mul_f32 v147, v147, v12
    v_mul_f32 v148, v148, v12
    v_mul_f32 v149, v149, v12
    v_mul_f32 v150, v150, v12
    v_mul_f32 v151, v151, v12
    v_mul_f32 v152, v152, v12
    v_mul_f32 v153, v153, v12
    v_mul_f32 v154, v154, v12
    v_mul_f32 v155, v155, v12
    v_mul_f32 v156, v156, v12
    v_mul_f32 v157, v157, v12
    v_mul_f32 v158, v158, v12
    v_mul_f32 v159, v159, v12
    v_mul_f32 v160, v160, v12
    v_mul_f32 v161, v161, v12
    v_mul_f32 v162, v162, v12
    v_mul_f32 v163, v163, v12
    v_mul_f32 v164, v164, v12
    v_mul_f32 v165, v165, v12
    v_mul_f32 v166, v166, v12
    v_mul_f32 v167, v167, v12
    v_mul_f32 v168, v168, v12
    v_mul_f32 v169, v169, v12
    v_mul_f32 v170, v170, v12
    v_mul_f32 v171, v171, v12
    v_mul_f32 v172, v172, v12
    v_mul_f32 v173, v173, v12
    v_mul_f32 v174, v174, v12
    v_mul_f32 v175, v175, v12
    v_mul_f32 v176, v176, v12
    v_mul_f32 v177, v177, v12
    v_mul_f32 v178, v178, v12
    v_mul_f32 v179, v179, v12
    v_mul_f32 v180, v180, v12
    v_mul_f32 v181, v181, v12
    v_mul_f32 v182, v182, v12
    v_mul_f32 v183, v183, v12
    v_mul_f32 v184, v184, v12
    v_mul_f32 v185, v185, v12
    v_mul_f32 v186, v186, v12
    v_mul_f32 v187, v187, v12
    v_mul_f32 v188, v188, v12
    v_mul_f32 v189, v189, v12
    v_mul_f32 v190, v190, v12
    v_mul_f32 v191, v191, v12
    v_mul_f32 v192, v192, v12
    v_mul_f32 v193, v193, v12
    v_mul_f32 v194, v194, v12
    v_mul_f32 v195, v195, v12
    v_mul_f32 v196, v196, v12
    v_mul_f32 v197, v197, v12
    v_mul_f32 v198, v198, v12
    v_mul_f32 v199, v199, v12
    v_mul_f32 v200, v200, v12
    v_mul_f32 v201, v201, v12
    v_mul_f32 v202, v202, v12
    v_mul_f32 v203, v203, v12
    v_mul_f32 v204, v204, v12
    v_mul_f32 v205, v205, v12
    v_mul_f32 v206, v206, v12
    v_mul_f32 v207, v207, v12
    v_mul_f32 v208, v208, v12
    v_mul_f32 v209, v209, v12
    v_mul_f32 v210, v210, v12
    v_mul_f32 v211, v211, v12
    v_mul_f32 v212, v212, v12
    v_mul_f32 v213, v213, v12
    v_mul_f32 v214, v214, v12
    v_mul_f32 v215, v215, v12
    v_mul_f32 v216, v216, v12
    v_mul_f32 v217, v217, v12
    v_mul_f32 v218, v218, v12
    v_mul_f32 v219, v219, v12
    v_mul_f32 v220, v220, v12
    v_mul_f32 v221, v221, v12
    v_mul_f32 v222, v222, v12
    v_mul_f32 v223, v223, v12
    v_mul_f32 v224, v224, v12
    v_mul_f32 v225, v225, v12
    v_mul_f32 v226, v226, v12
    v_mul_f32 v227, v227, v12
    v_mul_f32 v228, v228, v12
    v_mul_f32 v229, v229, v12
    v_mul_f32 v230, v230, v12
    v_mul_f32 v231, v231, v12
    s_nop 3
K2_NORESC_4:
    v_sub_f32 v16, v16, v6
    buffer_load_dwordx4 v1, s[12:15], s27 offen offset:2048 lds
    v_sub_f32 v17, v17, v6
    v_sub_f32 v18, v18, v6
    v_sub_f32 v19, v19, v6
    v_sub_f32 v20, v20, v6
    v_sub_f32 v21, v21, v6
    v_sub_f32 v22, v22, v6
    v_sub_f32 v23, v23, v6
    v_exp_f32 v16, v16
    v_exp_f32 v17, v17
    v_exp_f32 v18, v18
    v_exp_f32 v19, v19
    buffer_load_dwordx4 v1, s[12:15], s27 offen offset:3072 lds
    v_exp_f32 v20, v20
    v_exp_f32 v21, v21
    v_exp_f32 v22, v22
    v_exp_f32 v23, v23
    v_cvt_pk_bf16_f32 v32, v16, v17
    v_cvt_pk_bf16_f32 v33, v18, v19
    v_cvt_pk_bf16_f32 v34, v20, v21
    v_cvt_pk_bf16_f32 v35, v22, v23
    ds_read_b64_tr_b16 a[152:153], v244 offset:0
    ds_read_b64_tr_b16 a[154:155], v245 offset:0
    s_waitcnt lgkmcnt(10)
    s_add_u32 s29, s28, 903168
    buffer_load_dwordx4 a[232:235], v1, s[12:15], s29 offen
    v_mfma_f32_32x32x16_bf16 v[168:183], a[128:131], v[32:35], v[168:183]
    v_sub_f32 v24, v24, v6
    v_sub_f32 v25, v25, v6
    v_sub_f32 v26, v26, v6
    v_sub_f32 v27, v27, v6
    ds_read_b64_tr_b16 a[156:157], v246 offset:0
    ds_read_b64_tr_b16 a[158:159], v247 offset:0
    v_mfma_f32_32x32x16_bf16 v[184:199], a[132:135], v[32:35], v[184:199]
    s_add_u32 s29, s28, 904192
    buffer_load_dwordx4 a[236:239], v1, s[12:15], s29 offen
    v_sub_f32 v28, v28, v6
    v_sub_f32 v29, v29, v6
    v_sub_f32 v30, v30, v6
    v_sub_f32 v31, v31, v6
    ds_read_b64_tr_b16 a[128:129], v240 offset:8192
    ds_read_b64_tr_b16 a[130:131], v241 offset:8192
    s_waitcnt lgkmcnt(10)
    v_mfma_f32_32x32x16_bf16 v[200:215], a[136:139], v[32:35], v[200:215]
    s_add_u32 s29, s28, 905216
    buffer_load_dwordx4 a[240:243], v1, s[12:15], s29 offen
    v_exp_f32 v24, v24
    v_exp_f32 v25, v25
    v_exp_f32 v26, v26
    v_exp_f32 v27, v27
    ds_read_b64_tr_b16 a[132:133], v242 offset:8192
    ds_read_b64_tr_b16 a[134:135], v243 offset:8192
    v_mfma_f32_32x32x16_bf16 v[216:231], a[140:143], v[32:35], v[216:231]
    s_add_u32 s29, s28, 906240
    buffer_load_dwordx4 a[244:247], v1, s[12:15], s29 offen
    v_exp_f32 v28, v28
    v_exp_f32 v29, v29
    v_exp_f32 v30, v30
    v_exp_f32 v31, v31
    ds_read_b64_tr_b16 a[136:137], v244 offset:8192
    ds_read_b64_tr_b16 a[138:139], v245 offset:8192
    s_waitcnt lgkmcnt(10)
    v_mfma_f32_32x32x16_bf16 v[40:55], a[144:147], v[32:35], v[40:55]
    s_add_u32 s29, s28, 907264
    buffer_load_dwordx4 a[248:251], v1, s[12:15], s29 offen
    v_cvt_pk_bf16_f32 v36, v24, v25
    v_cvt_pk_bf16_f32 v37, v26, v27
    v_cvt_pk_bf16_f32 v38, v28, v29
    v_cvt_pk_bf16_f32 v39, v30, v31
    ds_read_b64_tr_b16 a[140:141], v246 offset:8192
    ds_read_b64_tr_b16 a[142:143], v247 offset:8192
    v_mfma_f32_32x32x16_bf16 v[56:71], a[148:151], v[32:35], v[56:71]
    v_add_f32 v11, v16, v17
    s_add_u32 s29, s28, 908288
    buffer_load_dwordx4 a[252:255], v1, s[12:15], s29 offen
    v_add_f32 v12, v18, v19
    v_add_f32 v11, v11, v20
    v_add_f32 v12, v12, v21
    ds_read_b64_tr_b16 a[144:145], v240 offset:36864
    ds_read_b64_tr_b16 a[146:147], v241 offset:36864
    s_waitcnt lgkmcnt(10)
    v_mfma_f32_32x32x16_bf16 v[72:87], a[152:155], v[32:35], v[72:87]
    v_add_f32 v11, v11, v22
    v_add_f32 v12, v12, v23
    v_add_f32 v11, v11, v24
    v_add_f32 v12, v12, v25
    ds_read_b64_tr_b16 a[148:149], v242 offset:36864
    ds_read_b64_tr_b16 a[150:151], v243 offset:36864
    v_mfma_f32_32x32x16_bf16 v[88:103], a[156:159], v[32:35], v[88:103]
    v_add_f32 v11, v11, v26
    v_add_f32 v12, v12, v27
    v_add_f32 v11, v11, v28
    v_add_f32 v12, v12, v29
    ds_read_b64_tr_b16 a[152:153], v244 offset:36864
    ds_read_b64_tr_b16 a[154:155], v245 offset:36864
    s_waitcnt lgkmcnt(10)
    v_mfma_f32_32x32x16_bf16 v[104:119], a[128:131], v[32:35], v[104:119]
    v_add_f32 v11, v11, v30
    v_add_f32 v12, v12, v31
    v_add_f32 v11, v11, v12
    v_add_f32 v7, v7, v11
    ds_read_b64_tr_b16 a[156:157], v246 offset:36864
    ds_read_b64_tr_b16 a[158:159], v247 offset:36864
    v_mfma_f32_32x32x16_bf16 v[120:135], a[132:135], v[32:35], v[120:135]
    ds_read_b64_tr_b16 a[128:129], v240 offset:4096
    ds_read_b64_tr_b16 a[130:131], v241 offset:4096
    s_waitcnt lgkmcnt(10)
    v_mfma_f32_32x32x16_bf16 v[136:151], a[136:139], v[32:35], v[136:151]
    ds_read_b64_tr_b16 a[132:133], v242 offset:4096
    ds_read_b64_tr_b16 a[134:135], v243 offset:4096
    v_mfma_f32_32x32x16_bf16 v[152:167], a[140:143], v[32:35], v[152:167]
    ds_read_b64_tr_b16 a[136:137], v244 offset:4096
    ds_read_b64_tr_b16 a[138:139], v245 offset:4096
    s_waitcnt lgkmcnt(10)
    v_mfma_f32_32x32x16_bf16 v[168:183], a[144:147], v[36:39], v[168:183]
    ds_read_b64_tr_b16 a[140:141], v246 offset:4096
    ds_read_b64_tr_b16 a[142:143], v247 offset:4096
    v_mfma_f32_32x32x16_bf16 v[184:199], a[148:151], v[36:39], v[184:199]
    ds_read_b64_tr_b16 a[144:145], v240 offset:12288
    ds_read_b64_tr_b16 a[146:147], v241 offset:12288
    s_waitcnt lgkmcnt(10)
    v_mfma_f32_32x32x16_bf16 v[200:215], a[152:155], v[36:39], v[200:215]
    ds_read_b64_tr_b16 a[148:149], v242 offset:12288
    ds_read_b64_tr_b16 a[150:151], v243 offset:12288
    v_mfma_f32_32x32x16_bf16 v[216:231], a[156:159], v[36:39], v[216:231]
    ds_read_b64_tr_b16 a[152:153], v244 offset:12288
    s_add_u32 m0, s19, 32768
    s_add_u32 s27, s22, 507904
    buffer_load_dwordx4 v1, s[12:15], s27 offen offset:0 lds
    ds_read_b64_tr_b16 a[154:155], v245 offset:12288
    s_waitcnt lgkmcnt(10)
    v_mfma_f32_32x32x16_bf16 v[40:55], a[128:131], v[36:39], v[40:55]
    buffer_load_dwordx4 v1, s[12:15], s27 offen offset:1024 lds
    ds_read_b64_tr_b16 a[156:157], v246 offset:12288
    ds_read_b64_tr_b16 a[158:159], v247 offset:12288
    v_mfma_f32_32x32x16_bf16 v[56:71], a[132:135], v[36:39], v[56:71]
    buffer_load_dwordx4 v1, s[12:15], s27 offen offset:2048 lds
    s_waitcnt lgkmcnt(8)
    v_mfma_f32_32x32x16_bf16 v[72:87], a[136:139], v[36:39], v[72:87]
    buffer_load_dwordx4 v1, s[12:15], s27 offen offset:3072 lds
    v_mfma_f32_32x32x16_bf16 v[88:103], a[140:143], v[36:39], v[88:103]
    s_add_u32 m0, s19, 36864
    s_add_u32 s27, s22, 512000
    buffer_load_dwordx4 v1, s[12:15], s27 offen offset:0 lds
    s_waitcnt lgkmcnt(4)
    v_mfma_f32_32x32x16_bf16 v[104:119], a[144:147], v[36:39], v[104:119]
    buffer_load_dwordx4 v1, s[12:15], s27 offen offset:1024 lds
    v_mfma_f32_32x32x16_bf16 v[120:135], a[148:151], v[36:39], v[120:135]
    buffer_load_dwordx4 v1, s[12:15], s27 offen offset:2048 lds
    s_waitcnt lgkmcnt(0)
    v_mfma_f32_32x32x16_bf16 v[136:151], a[152:155], v[36:39], v[136:151]
    buffer_load_dwordx4 v1, s[12:15], s27 offen offset:3072 lds
    v_mfma_f32_32x32x16_bf16 v[152:167], a[156:159], v[36:39], v[152:167]
    s_cmp_eq_u32 s16, 3
    s_cbranch_scc1 K2_LOOPDONE
    s_waitcnt vmcnt(14)
    ds_read_b128 a[96:99], v232 offset:16384
    ds_read_b128 a[100:103], v233 offset:16384
    ds_read_b128 a[104:107], v234 offset:16384
    ds_read_b128 a[108:111], v235 offset:16384
    ds_read_b128 a[112:115], v236 offset:16384
    ds_read_b128 a[116:119], v237 offset:16384
    ds_read_b128 a[120:123], v238 offset:16384
    s_waitcnt lgkmcnt(5)
    v_mfma_f32_32x32x16_bf16 v[16:31], a[96:99], a[0:3], 0
    ds_read_b128 a[124:127], v239 offset:16384
    v_mfma_f32_32x32x16_bf16 v[16:31], a[100:103], a[4:7], v[16:31]
    ds_read_b128 a[96:99], v232 offset:24576
    s_waitcnt lgkmcnt(5)
    v_mfma_f32_32x32x16_bf16 v[16:31], a[104:107], a[8:11], v[16:31]
    ds_read_b128 a[100:103], v233 offset:24576
    v_mfma_f32_32x32x16_bf16 v[16:31], a[108:111], a[12:15], v[16:31]
    ds_read_b128 a[104:107], v234 offset:24576
    s_waitcnt lgkmcnt(5)
    v_mfma_f32_32x32x16_bf16 v[16:31], a[112:115], a[16:19], v[16:31]
    ds_read_b128 a[108:111], v235 offset:24576
    v_mfma_f32_32x32x16_bf16 v[16:31], a[116:119], a[20:23], v[16:31]
    ds_read_b128 a[112:115], v236 offset:24576
    s_waitcnt lgkmcnt(5)
    v_mfma_f32_32x32x16_bf16 v[16:31], a[120:123], a[24:27], v[16:31]
    ds_read_b128 a[116:119], v237 offset:24576
    v_mfma_f32_32x32x16_bf16 v[16:31], a[124:127], a[28:31], v[16:31]
    ds_read_b128 a[120:123], v238 offset:24576
    s_waitcnt lgkmcnt(5)
    v_mfma_f32_32x32x16_bf16 v[16:31], a[96:99], a[32:35], v[16:31]
    ds_read_b128 a[124:127], v239 offset:24576
    v_mfma_f32_32x32x16_bf16 v[16:31], a[100:103], a[36:39], v[16:31]
    s_waitcnt vmcnt(0)
    ds_read_b128 a[96:99], v232 offset:32768
    s_waitcnt lgkmcnt(5)
    v_mfma_f32_32x32x16_bf16 v[16:31], a[104:107], a[40:43], v[16:31]
    ds_read_b128 a[100:103], v233 offset:32768
    v_mfma_f32_32x32x16_bf16 v[16:31], a[108:111], a[44:47], v[16:31]
    ds_read_b128 a[104:107], v234 offset:32768
    s_waitcnt lgkmcnt(5)
    v_mfma_f32_32x32x16_bf16 v[16:31], a[112:115], a[48:51], v[16:31]
    ds_read_b128 a[108:111], v235 offset:32768
    v_mfma_f32_32x32x16_bf16 v[16:31], a[116:119], a[52:55], v[16:31]
    ds_read_b128 a[112:115], v236 offset:32768
    s_waitcnt lgkmcnt(5)
    v_mfma_f32_32x32x16_bf16 v[16:31], a[120:123], a[56:59], v[16:31]
    ds_read_b128 a[116:119], v237 offset:32768
    v_mfma_f32_32x32x16_bf16 v[16:31], a[124:127], a[60:63], v[16:31]
    ds_read_b128 a[120:123], v238 offset:32768
    s_waitcnt lgkmcnt(5)
    v_mfma_f32_32x32x16_bf16 v[16:31], a[96:99], a[64:67], v[16:31]
    ds_read_b128 a[124:127], v239 offset:32768
    v_mfma_f32_32x32x16_bf16 v[16:31], a[100:103], a[68:71], v[16:31]
    s_waitcnt lgkmcnt(4)
    v_mfma_f32_32x32x16_bf16 v[16:31], a[104:107], a[72:75], v[16:31]
    v_mfma_f32_32x32x16_bf16 v[16:31], a[108:111], a[76:79], v[16:31]
    s_waitcnt lgkmcnt(2)
    v_mfma_f32_32x32x16_bf16 v[16:31], a[112:115], a[80:83], v[16:31]
    v_mfma_f32_32x32x16_bf16 v[16:31], a[116:119], a[84:87], v[16:31]
    s_waitcnt lgkmcnt(0)
    v_mfma_f32_32x32x16_bf16 v[16:31], a[120:123], a[88:91], v[16:31]
    v_mfma_f32_32x32x16_bf16 v[16:31], a[124:127], a[92:95], v[16:31]
    ds_read_b64_tr_b16 a[128:129], v240 offset:32768
    ds_read_b64_tr_b16 a[130:131], v241 offset:32768
    ds_read_b64_tr_b16 a[132:133], v242 offset:32768
    ds_read_b64_tr_b16 a[134:135], v243 offset:32768
    ds_read_b64_tr_b16 a[136:137], v244 offset:32768
    ds_read_b64_tr_b16 a[138:139], v245 offset:32768
    ds_read_b64_tr_b16 a[140:141], v246 offset:32768
    ds_read_b64_tr_b16 a[142:143], v247 offset:32768
    ds_read_b64_tr_b16 a[144:145], v240 offset:16384
    ds_read_b64_tr_b16 a[146:147], v241 offset:16384
    ds_read_b64_tr_b16 a[148:149], v242 offset:16384
    ds_read_b64_tr_b16 a[150:151], v243 offset:16384
    s_cmp_lg_u32 s16, 2
    s_cbranch_scc1 K2_NOMASK
    v_mov_b32 v29, s25
    v_mov_b32 v30, s25
    v_mov_b32 v31, s25
    s_mov_b32 exec_lo, 0
    v_mov_b32 v28, s25
    s_mov_b32 exec_lo, -1
    s_nop 3
K2_NOMASK:
    v_max3_f32 v11, v16, v17, v18
    v_max3_f32 v12, v19, v20, v21
    v_max3_f32 v11, v11, v22, v23
    v_max3_f32 v12, v12, v24, v25
    v_max3_f32 v11, v11, v26, v27
    v_max3_f32 v12, v12, v28, v29
    v_max3_f32 v11, v11, v30, v31
    v_max_f32 v11, v11, v12
    v_mov_b32 v12, v11
    s_nop 1
    v_permlane32_swap_b32 v11, v12
    v_max_f32 v11, v11, v12
    v_sub_f32 v12, v11, v6
    v_cmp_lt_f32 vcc, s24, v12
    s_nop 1
    s_cbranch_vccz K2_NORESC_5
    v_max_f32 v11, v11, v6
    v_sub_f32 v12, v6, v11
    v_exp_f32 v12, v12
    v_mov_b32 v6, v11
    v_mul_f32 v7, v7, v12
    v_mul_f32 v40, v40, v12
    v_mul_f32 v41, v41, v12
    v_mul_f32 v42, v42, v12
    v_mul_f32 v43, v43, v12
    v_mul_f32 v44, v44, v12
    v_mul_f32 v45, v45, v12
    v_mul_f32 v46, v46, v12
    v_mul_f32 v47, v47, v12
    v_mul_f32 v48, v48, v12
    v_mul_f32 v49, v49, v12
    v_mul_f32 v50, v50, v12
    v_mul_f32 v51, v51, v12
    v_mul_f32 v52, v52, v12
    v_mul_f32 v53, v53, v12
    v_mul_f32 v54, v54, v12
    v_mul_f32 v55, v55, v12
    v_mul_f32 v56, v56, v12
    v_mul_f32 v57, v57, v12
    v_mul_f32 v58, v58, v12
    v_mul_f32 v59, v59, v12
    v_mul_f32 v60, v60, v12
    v_mul_f32 v61, v61, v12
    v_mul_f32 v62, v62, v12
    v_mul_f32 v63, v63, v12
    v_mul_f32 v64, v64, v12
    v_mul_f32 v65, v65, v12
    v_mul_f32 v66, v66, v12
    v_mul_f32 v67, v67, v12
    v_mul_f32 v68, v68, v12
    v_mul_f32 v69, v69, v12
    v_mul_f32 v70, v70, v12
    v_mul_f32 v71, v71, v12
    v_mul_f32 v72, v72, v12
    v_mul_f32 v73, v73, v12
    v_mul_f32 v74, v74, v12
    v_mul_f32 v75, v75, v12
    v_mul_f32 v76, v76, v12
    v_mul_f32 v77, v77, v12
    v_mul_f32 v78, v78, v12
    v_mul_f32 v79, v79, v12
    v_mul_f32 v80, v80, v12
    v_mul_f32 v81, v81, v12
    v_mul_f32 v82, v82, v12
    v_mul_f32 v83, v83, v12
    v_mul_f32 v84, v84, v12
    v_mul_f32 v85, v85, v12
    v_mul_f32 v86, v86, v12
    v_mul_f32 v87, v87, v12
    v_mul_f32 v88, v88, v12
    v_mul_f32 v89, v89, v12
    v_mul_f32 v90, v90, v12
    v_mul_f32 v91, v91, v12
    v_mul_f32 v92, v92, v12
    v_mul_f32 v93, v93, v12
    v_mul_f32 v94, v94, v12
    v_mul_f32 v95, v95, v12
    v_mul_f32 v96, v96, v12
    v_mul_f32 v97, v97, v12
    v_mul_f32 v98, v98, v12
    v_mul_f32 v99, v99, v12
    v_mul_f32 v100, v100, v12
    v_mul_f32 v101, v101, v12
    v_mul_f32 v102, v102, v12
    v_mul_f32 v103, v103, v12
    v_mul_f32 v104, v104, v12
    v_mul_f32 v105, v105, v12
    v_mul_f32 v106, v106, v12
    v_mul_f32 v107, v107, v12
    v_mul_f32 v108, v108, v12
    v_mul_f32 v109, v109, v12
    v_mul_f32 v110, v110, v12
    v_mul_f32 v111, v111, v12
    v_mul_f32 v112, v112, v12
    v_mul_f32 v113, v113, v12
    v_mul_f32 v114, v114, v12
    v_mul_f32 v115, v115, v12
    v_mul_f32 v116, v116, v12
    v_mul_f32 v117, v117, v12
    v_mul_f32 v118, v118, v12
    v_mul_f32 v119, v119, v12
    v_mul_f32 v120, v120, v12
    v_mul_f32 v121, v121, v12
    v_mul_f32 v122, v122, v12
    v_mul_f32 v123, v123, v12
    v_mul_f32 v124, v124, v12
    v_mul_f32 v125, v125, v12
    v_mul_f32 v126, v126, v12
    v_mul_f32 v127, v127, v12
    v_mul_f32 v128, v128, v12
    v_mul_f32 v129, v129, v12
    v_mul_f32 v130, v130, v12
    v_mul_f32 v131, v131, v12
    v_mul_f32 v132, v132, v12
    v_mul_f32 v133, v133, v12
    v_mul_f32 v134, v134, v12
    v_mul_f32 v135, v135, v12
    v_mul_f32 v136, v136, v12
    v_mul_f32 v137, v137, v12
    v_mul_f32 v138, v138, v12
    v_mul_f32 v139, v139, v12
    v_mul_f32 v140, v140, v12
    v_mul_f32 v141, v141, v12
    v_mul_f32 v142, v142, v12
    v_mul_f32 v143, v143, v12
    v_mul_f32 v144, v144, v12
    v_mul_f32 v145, v145, v12
    v_mul_f32 v146, v146, v12
    v_mul_f32 v147, v147, v12
    v_mul_f32 v148, v148, v12
    v_mul_f32 v149, v149, v12
    v_mul_f32 v150, v150, v12
    v_mul_f32 v151, v151, v12
    v_mul_f32 v152, v152, v12
    v_mul_f32 v153, v153, v12
    v_mul_f32 v154, v154, v12
    v_mul_f32 v155, v155, v12
    v_mul_f32 v156, v156, v12
    v_mul_f32 v157, v157, v12
    v_mul_f32 v158, v158, v12
    v_mul_f32 v159, v159, v12
    v_mul_f32 v160, v160, v12
    v_mul_f32 v161, v161, v12
    v_mul_f32 v162, v162, v12
    v_mul_f32 v163, v163, v12
    v_mul_f32 v164, v164, v12
    v_mul_f32 v165, v165, v12
    v_mul_f32 v166, v166, v12
    v_mul_f32 v167, v167, v12
    v_mul_f32 v168, v168, v12
    v_mul_f32 v169, v169, v12
    v_mul_f32 v170, v170, v12
    v_mul_f32 v171, v171, v12
    v_mul_f32 v172, v172, v12
    v_mul_f32 v173, v173, v12
    v_mul_f32 v174, v174, v12
    v_mul_f32 v175, v175, v12
    v_mul_f32 v176, v176, v12
    v_mul_f32 v177, v177, v12
    v_mul_f32 v178, v178, v12
    v_mul_f32 v179, v179, v12
    v_mul_f32 v180, v180, v12
    v_mul_f32 v181, v181, v12
    v_mul_f32 v182, v182, v12
    v_mul_f32 v183, v183, v12
    v_mul_f32 v184, v184, v12
    v_mul_f32 v185, v185, v12
    v_mul_f32 v186, v186, v12
    v_mul_f32 v187, v187, v12
    v_mul_f32 v188, v188, v12
    v_mul_f32 v189, v189, v12
    v_mul_f32 v190, v190, v12
    v_mul_f32 v191, v191, v12
    v_mul_f32 v192, v192, v12
    v_mul_f32 v193, v193, v12
    v_mul_f32 v194, v194, v12
    v_mul_f32 v195, v195, v12
    v_mul_f32 v196, v196, v12
    v_mul_f32 v197, v197, v12
    v_mul_f32 v198, v198, v12
    v_mul_f32 v199, v199, v12
    v_mul_f32 v200, v200, v12
    v_mul_f32 v201, v201, v12
    v_mul_f32 v202, v202, v12
    v_mul_f32 v203, v203, v12
    v_mul_f32 v204, v204, v12
    v_mul_f32 v205, v205, v12
    v_mul_f32 v206, v206, v12
    v_mul_f32 v207, v207, v12
    v_mul_f32 v208, v208, v12
    v_mul_f32 v209, v209, v12
    v_mul_f32 v210, v210, v12
    v_mul_f32 v211, v211, v12
    v_mul_f32 v212, v212, v12
    v_mul_f32 v213, v213, v12
    v_mul_f32 v214, v214, v12
    v_mul_f32 v215, v215, v12
    v_mul_f32 v216, v216, v12
    v_mul_f32 v217, v217, v12
    v_mul_f32 v218, v218, v12
    v_mul_f32 v219, v219, v12
    v_mul_f32 v220, v220, v12
    v_mul_f32 v221, v221, v12
    v_mul_f32 v222, v222, v12
    v_mul_f32 v223, v223, v12
    v_mul_f32 v224, v224, v12
    v_mul_f32 v225, v225, v12
    v_mul_f32 v226, v226, v12
    v_mul_f32 v227, v227, v12
    v_mul_f32 v228, v228, v12
    v_mul_f32 v229, v229, v12
    v_mul_f32 v230, v230, v12
    v_mul_f32 v231, v231, v12
    s_nop 3
K2_NORESC_5:
    v_sub_f32 v16, v16, v6
    v_sub_f32 v17, v17, v6
    v_sub_f32 v18, v18, v6
    v_sub_f32 v19, v19, v6
    v_sub_f32 v20, v20, v6
    v_sub_f32 v21, v21, v6
    v_sub_f32 v22, v22, v6
    v_sub_f32 v23, v23, v6
    v_exp_f32 v16, v16
    v_exp_f32 v17, v17
    v_exp_f32 v18, v18
    v_exp_f32 v19, v19
    v_exp_f32 v20, v20
    v_exp_f32 v21, v21
    v_exp_f32 v22, v22
    v_exp_f32 v23, v23
    v_cvt_pk_bf16_f32 v32, v16, v17
    v_cvt_pk_bf16_f32 v33, v18, v19
    v_cvt_pk_bf16_f32 v34, v20, v21
    v_cvt_pk_bf16_f32 v35, v22, v23
    ds_read_b64_tr_b16 a[152:153], v244 offset:16384
    ds_read_b64_tr_b16 a[154:155], v245 offset:16384
    s_waitcnt lgkmcnt(10)
    v_mfma_f32_32x32x16_bf16 v[168:183], a[128:131], v[32:35], v[168:183]
    v_sub_f32 v24, v24, v6
    v_sub_f32 v25, v25, v6
    v_sub_f32 v26, v26, v6
    v_sub_f32 v27, v27, v6
    ds_read_b64_tr_b16 a[156:157], v246 offset:16384
    ds_read_b64_tr_b16 a[158:159], v247 offset:16384
    v_mfma_f32_32x32x16_bf16 v[184:199], a[132:135], v[32:35], v[184:199]
    v_sub_f32 v28, v28, v6
    v_sub_f32 v29, v29, v6
    v_sub_f32 v30, v30, v6
    v_sub_f32 v31, v31, v6
    ds_read_b64_tr_b16 a[128:129], v240 offset:24576
    ds_read_b64_tr_b16 a[130:131], v241 offset:24576
    s_waitcnt lgkmcnt(10)
    v_mfma_f32_32x32x16_bf16 v[200:215], a[136:139], v[32:35], v[200:215]
    v_exp_f32 v24, v24
    v_exp_f32 v25, v25
    v_exp_f32 v26, v26
    v_exp_f32 v27, v27
    ds_read_b64_tr_b16 a[132:133], v242 offset:24576
    ds_read_b64_tr_b16 a[134:135], v243 offset:24576
    v_mfma_f32_32x32x16_bf16 v[216:231], a[140:143], v[32:35], v[216:231]
    v_exp_f32 v28, v28
    v_exp_f32 v29, v29
    v_exp_f32 v30, v30
    v_exp_f32 v31, v31
    ds_read_b64_tr_b16 a[136:137], v244 offset:24576
    ds_read_b64_tr_b16 a[138:139], v245 offset:24576
    s_waitcnt lgkmcnt(10)
    v_mfma_f32_32x32x16_bf16 v[40:55], a[144:147], v[32:35], v[40:55]
    v_cvt_pk_bf16_f32 v36, v24, v25
    v_cvt_pk_bf16_f32 v37, v26, v27
    v_cvt_pk_bf16_f32 v38, v28, v29
    v_cvt_pk_bf16_f32 v39, v30, v31
    ds_read_b64_tr_b16 a[140:141], v246 offset:24576
    ds_read_b64_tr_b16 a[142:143], v247 offset:24576
    v_mfma_f32_32x32x16_bf16 v[56:71], a[148:151], v[32:35], v[56:71]
    v_add_f32 v11, v16, v17
    v_add_f32 v12, v18, v19
    v_add_f32 v11, v11, v20
    v_add_f32 v12, v12, v21
    ds_read_b64_tr_b16 a[144:145], v240 offset:36864
    ds_read_b64_tr_b16 a[146:147], v241 offset:36864
    s_waitcnt lgkmcnt(10)
    v_mfma_f32_32x32x16_bf16 v[72:87], a[152:155], v[32:35], v[72:87]
    v_add_f32 v11, v11, v22
    v_add_f32 v12, v12, v23
    v_add_f32 v11, v11, v24
    v_add_f32 v12, v12, v25
    ds_read_b64_tr_b16 a[148:149], v242 offset:36864
    ds_read_b64_tr_b16 a[150:151], v243 offset:36864
    v_mfma_f32_32x32x16_bf16 v[88:103], a[156:159], v[32:35], v[88:103]
    v_add_f32 v11, v11, v26
    v_add_f32 v12, v12, v27
    v_add_f32 v11, v11, v28
    v_add_f32 v12, v12, v29
    ds_read_b64_tr_b16 a[152:153], v244 offset:36864
    ds_read_b64_tr_b16 a[154:155], v245 offset:36864
    s_waitcnt lgkmcnt(10)
    v_mfma_f32_32x32x16_bf16 v[104:119], a[128:131], v[32:35], v[104:119]
    v_add_f32 v11, v11, v30
    v_add_f32 v12, v12, v31
    v_add_f32 v11, v11, v12
    v_add_f32 v7, v7, v11
    ds_read_b64_tr_b16 a[156:157], v246 offset:36864
    ds_read_b64_tr_b16 a[158:159], v247 offset:36864
    v_mfma_f32_32x32x16_bf16 v[120:135], a[132:135], v[32:35], v[120:135]
    ds_read_b64_tr_b16 a[128:129], v240 offset:20480
    ds_read_b64_tr_b16 a[130:131], v241 offset:20480
    s_waitcnt lgkmcnt(10)
    v_mfma_f32_32x32x16_bf16 v[136:151], a[136:139], v[32:35], v[136:151]
    ds_read_b64_tr_b16 a[132:133], v242 offset:20480
    ds_read_b64_tr_b16 a[134:135], v243 offset:20480
    v_mfma_f32_32x32x16_bf16 v[152:167], a[140:143], v[32:35], v[152:167]
    ds_read_b64_tr_b16 a[136:137], v244 offset:20480
    ds_read_b64_tr_b16 a[138:139], v245 offset:20480
    s_waitcnt lgkmcnt(10)
    v_mfma_f32_32x32x16_bf16 v[168:183], a[144:147], v[36:39], v[168:183]
    ds_read_b64_tr_b16 a[140:141], v246 offset:20480
    ds_read_b64_tr_b16 a[142:143], v247 offset:20480
    v_mfma_f32_32x32x16_bf16 v[184:199], a[148:151], v[36:39], v[184:199]
    ds_read_b64_tr_b16 a[144:145], v240 offset:28672
    ds_read_b64_tr_b16 a[146:147], v241 offset:28672
    s_waitcnt lgkmcnt(10)
    v_mfma_f32_32x32x16_bf16 v[200:215], a[152:155], v[36:39], v[200:215]
    ds_read_b64_tr_b16 a[148:149], v242 offset:28672
    ds_read_b64_tr_b16 a[150:151], v243 offset:28672
    v_mfma_f32_32x32x16_bf16 v[216:231], a[156:159], v[36:39], v[216:231]
    ds_read_b64_tr_b16 a[152:153], v244 offset:28672
    ds_read_b64_tr_b16 a[154:155], v245 offset:28672
    s_waitcnt lgkmcnt(10)
    v_mfma_f32_32x32x16_bf16 v[40:55], a[128:131], v[36:39], v[40:55]
    ds_read_b64_tr_b16 a[156:157], v246 offset:28672
    ds_read_b64_tr_b16 a[158:159], v247 offset:28672
    v_mfma_f32_32x32x16_bf16 v[56:71], a[132:135], v[36:39], v[56:71]
    s_waitcnt lgkmcnt(8)
    v_mfma_f32_32x32x16_bf16 v[72:87], a[136:139], v[36:39], v[72:87]
    v_mfma_f32_32x32x16_bf16 v[88:103], a[140:143], v[36:39], v[88:103]
    s_waitcnt lgkmcnt(4)
    v_mfma_f32_32x32x16_bf16 v[104:119], a[144:147], v[36:39], v[104:119]
    v_mfma_f32_32x32x16_bf16 v[120:135], a[148:151], v[36:39], v[120:135]
    s_waitcnt lgkmcnt(0)
    v_mfma_f32_32x32x16_bf16 v[136:151], a[152:155], v[36:39], v[136:151]
    v_mfma_f32_32x32x16_bf16 v[152:167], a[156:159], v[36:39], v[152:167]
    s_nop 11
K2_LOOPDONE:
    s_nop 11
    s_waitcnt vmcnt(0)
    s_waitcnt lgkmcnt(0)
    v_lshrrev_b32 v11, 3, v8
    s_lshl_b32 s26, s16, 3
    v_add_u32 v11, s26, v11
    v_and_b32 v12, 7, v8
    v_mul_u32_u24 v5, 784, v11
    v_lshl_add_u32 v5, v12, 4, v5
    v_mul_u32_u24 v13, 768, v11
    v_lshl_add_u32 v13, v12, 4, v13
    s_add_u32 s26, s21, 10485760
    buffer_load_dwordx4 v[232:235], v13, s[12:15], s26 offen offset:0
    buffer_load_dwordx4 v[236:239], v13, s[12:15], s26 offen offset:128
    buffer_load_dwordx4 v[240:243], v13, s[12:15], s26 offen offset:256
    buffer_load_dwordx4 v[244:247], v13, s[12:15], s26 offen offset:384
    buffer_load_dwordx4 v[248:251], v13, s[12:15], s26 offen offset:512
    buffer_load_dwordx4 v[252:255], v13, s[12:15], s26 offen offset:640
    s_lshl_b32 s26, s18, 5
    v_add_u32 v11, s26, v11
    s_movk_i32 s27, 729
    v_cmp_gt_u32 vcc, s27, v11
    s_mul_i32 s27, s17, 729
    s_add_u32 s27, s27, s26
    s_mul_i32 s27, s27, 768
    v_add_u32 v13, s27, v13
    v_mov_b32 v12, 2130706432
    v_cndmask_b32 v15, v12, v13, vcc
    v_mov_b32 v12, v7
    s_add_u32 s29, s28, 909312
    buffer_load_dwordx4 a[0:3], v1, s[12:15], s29 offen
    v_permlane32_swap_b32 v7, v12
    v_add_f32 v7, v7, v12
    v_lshlrev_b32 v11, 3, v9
    v_add_u32 v12, s19, v11
    ds_write_b64 v12, v[6:7] offset:36864
    v_add_u32 v13, s19, v1
    ds_write_b128 v13, v[56:59] offset:0
    ds_write_b128 v13, v[60:63] offset:1024
    ds_write_b128 v13, v[64:67] offset:2048
    ds_write_b128 v13, v[68:71] offset:3072
    ds_write_b128 v13, v[120:123] offset:4096
    ds_write_b128 v13, v[124:127] offset:5120
    ds_write_b128 v13, v[128:131] offset:6144
    ds_write_b128 v13, v[132:135] offset:7168
    ds_write_b128 v13, v[184:187] offset:8192
    s_add_u32 s29, s28, 910336
    buffer_load_dwordx4 a[4:7], v1, s[12:15], s29 offen
    ds_write_b128 v13, v[188:191] offset:9216
    ds_write_b128 v13, v[192:195] offset:10240
    ds_write_b128 v13, v[196:199] offset:11264
    ds_write_b128 v13, v[72:75] offset:12288
    ds_write_b128 v13, v[76:79] offset:13312
    ds_write_b128 v13, v[80:83] offset:14336
    ds_write_b128 v13, v[84:87] offset:15360
    ds_write_b128 v13, v[136:139] offset:16384
    ds_write_b128 v13, v[140:143] offset:17408
    ds_write_b128 v13, v[144:147] offset:18432
    ds_write_b128 v13, v[148:151] offset:19456
    ds_write_b128 v13, v[200:203] offset:20480
    ds_write_b128 v13, v[204:207] offset:21504
    ds_write_b128 v13, v[208:211] offset:22528
    ds_write_b128 v13, v[212:215] offset:23552
    s_add_u32 s29, s28, 911360
    buffer_load_dwordx4 a[8:11], v1, s[12:15], s29 offen
    ds_write_b128 v13, v[88:91] offset:24576
    ds_write_b128 v13, v[92:95] offset:25600
    ds_write_b128 v13, v[96:99] offset:26624
    ds_write_b128 v13, v[100:103] offset:27648
    ds_write_b128 v13, v[152:155] offset:28672
    ds_write_b128 v13, v[156:159] offset:29696
    ds_write_b128 v13, v[160:163] offset:30720
    ds_write_b128 v13, v[164:167] offset:31744
    ds_write_b128 v13, v[216:219] offset:32768
    ds_write_b128 v13, v[220:223] offset:33792
    ds_write_b128 v13, v[224:227] offset:34816
    ds_write_b128 v13, v[228:231] offset:35840
    s_sub_u32 s26, s16, 1
    s_and_b32 s26, s26, 3
    s_mul_i32 s26, s26, 40960
    s_add_u32 s29, s28, 912384
    buffer_load_dwordx4 a[12:15], v1, s[12:15], s29 offen
    v_add_u32 v2, s26, v1
    v_add_u32 v33, s26, v11
    s_sub_u32 s26, s16, 2
    s_and_b32 s26, s26, 3
    s_mul_i32 s26, s26, 40960
    v_add_u32 v3, s26, v1
    v_add_u32 v34, s26, v11
    s_sub_u32 s26, s16, 3
    s_and_b32 s26, s26, 3
    s_mul_i32 s26, s26, 40960
    v_add_u32 v4, s26, v1
    v_add_u32 v35, s26, v11
    s_add_u32 s29, s28, 913408
    buffer_load_dwordx4 a[16:19], v1, s[12:15], s29 offen
    s_add_u32 s29, s28, 914432
    buffer_load_dwordx4 a[20:23], v1, s[12:15], s29 offen
    s_add_u32 s29, s28, 915456
    buffer_load_dwordx4 a[24:27], v1, s[12:15], s29 offen
    s_add_u32 s29, s28, 916480
    buffer_load_dwordx4 a[28:31], v1, s[12:15], s29 offen
    s_add_u32 s29, s28, 917504
    buffer_load_dwordx4 a[32:35], v1, s[12:15], s29 offen
    s_add_u32 s29, s28, 918528
    buffer_load_dwordx4 a[36:39], v1, s[12:15], s29 offen
    s_add_u32 s29, s28, 919552
    buffer_load_dwordx4 a[40:43], v1, s[12:15], s29 offen
    s_add_u32 s29, s28, 920576
    buffer_load_dwordx4 a[44:47], v1, s[12:15], s29 offen
    s_waitcnt lgkmcnt(0)
    s_barrier
    v_mov_b32 v16, v6
    v_mov_b32 v17, v7
    ds_read_b64 v[18:19], v33 offset:36864
    ds_read_b64 v[20:21], v34 offset:36864
    ds_read_b64 v[22:23], v35 offset:36864
    ds_read_b128 v[56:59], v2 offset:0
    ds_read_b128 v[60:63], v2 offset:1024
    ds_read_b128 v[64:67], v2 offset:2048
    ds_read_b128 v[68:71], v2 offset:3072
    ds_read_b128 v[120:123], v2 offset:4096
    ds_read_b128 v[124:127], v2 offset:5120
    ds_read_b128 v[128:131], v2 offset:6144
    ds_read_b128 v[132:135], v2 offset:7168
    s_add_u32 s29, s28, 921600
    buffer_load_dwordx4 a[48:51], v1, s[12:15], s29 offen
    ds_read_b128 v[184:187], v2 offset:8192
    ds_read_b128 v[188:191], v2 offset:9216
    ds_read_b128 v[192:195], v2 offset:10240
    ds_read_b128 v[196:199], v2 offset:11264
    ds_read_b128 v[72:75], v3 offset:12288
    ds_read_b128 v[76:79], v3 offset:13312
    ds_read_b128 v[80:83], v3 offset:14336
    ds_read_b128 v[84:87], v3 offset:15360
    ds_read_b128 v[136:139], v3 offset:16384
    ds_read_b128 v[140:143], v3 offset:17408
    ds_read_b128 v[144:147], v3 offset:18432
    ds_read_b128 v[148:151], v3 offset:19456
    ds_read_b128 v[200:203], v3 offset:20480
    ds_read_b128 v[204:207], v3 offset:21504
    ds_read_b128 v[208:211], v3 offset:22528
    s_add_u32 s29, s28, 922624
    buffer_load_dwordx4 a[52:55], v1, s[12:15], s29 offen
    ds_read_b128 v[212:215], v3 offset:23552
    ds_read_b128 v[88:91], v4 offset:24576
    ds_read_b128 v[92:95], v4 offset:25600
    ds_read_b128 v[96:99], v4 offset:26624
    ds_read_b128 v[100:103], v4 offset:27648
    ds_read_b128 v[152:155], v4 offset:28672
    ds_read_b128 v[156:159], v4 offset:29696
    ds_read_b128 v[160:163], v4 offset:30720
    ds_read_b128 v[164:167], v4 offset:31744
    ds_read_b128 v[216:219], v4 offset:32768
    ds_read_b128 v[220:223], v4 offset:33792
    ds_read_b128 v[224:227], v4 offset:34816
    ds_read_b128 v[228:231], v4 offset:35840
    s_waitcnt lgkmcnt(15)
    v_max3_f32 v12, v16, v18, v20
    s_add_u32 s29, s28, 923648
    buffer_load_dwordx4 a[56:59], v1, s[12:15], s29 offen
    v_max_f32 v12, v12, v22
    v_sub_f32 v16, v16, v12
    v_sub_f32 v18, v18, v12
    v_sub_f32 v20, v20, v12
    v_sub_f32 v22, v22, v12
    v_exp_f32 v16, v16
    v_exp_f32 v18, v18
    v_exp_f32 v20, v20
    v_exp_f32 v22, v22
    v_mul_f32 v13, v16, v17
    v_fmac_f32 v13, v18, v19
    s_add_u32 s29, s28, 924672
    buffer_load_dwordx4 a[60:63], v1, s[12:15], s29 offen
    v_fmac_f32 v13, v20, v21
    v_fmac_f32 v13, v22, v23
    v_rcp_f32 v13, v13
    s_nop 0
    v_mul_f32 v16, v16, v13
    v_mul_f32 v18, v18, v13
    v_mul_f32 v20, v20, v13
    v_mul_f32 v22, v22, v13
    v_pk_mul_f32 v[40:41], v[40:41], v[16:17] op_sel_hi:[1,0]
    v_pk_mul_f32 v[42:43], v[42:43], v[16:17] op_sel_hi:[1,0]
    v_pk_mul_f32 v[44:45], v[44:45], v[16:17] op_sel_hi:[1,0]
    v_pk_mul_f32 v[46:47], v[46:47], v[16:17] op_sel_hi:[1,0]
    v_pk_mul_f32 v[48:49], v[48:49], v[16:17] op_sel_hi:[1,0]
    v_pk_mul_f32 v[50:51], v[50:51], v[16:17] op_sel_hi:[1,0]
    s_add_u32 s29, s28, 925696
    buffer_load_dwordx4 a[64:67], v1, s[12:15], s29 offen
    v_pk_mul_f32 v[52:53], v[52:53], v[16:17] op_sel_hi:[1,0]
    v_pk_mul_f32 v[54:55], v[54:55], v[16:17] op_sel_hi:[1,0]
    v_pk_mul_f32 v[104:105], v[104:105], v[16:17] op_sel_hi:[1,0]
    v_pk_mul_f32 v[106:107], v[106:107], v[16:17] op_sel_hi:[1,0]
    v_pk_mul_f32 v[108:109], v[108:109], v[16:17] op_sel_hi:[1,0]
    v_pk_mul_f32 v[110:111], v[110:111], v[16:17] op_sel_hi:[1,0]
    v_pk_mul_f32 v[112:113], v[112:113], v[16:17] op_sel_hi:[1,0]
    v_pk_mul_f32 v[114:115], v[114:115], v[16:17] op_sel_hi:[1,0]
    v_pk_mul_f32 v[116:117], v[116:117], v[16:17] op_sel_hi:[1,0]
    v_pk_mul_f32 v[118:119], v[118:119], v[16:17] op_sel_hi:[1,0]
    v_pk_mul_f32 v[168:169], v[168:169], v[16:17] op_sel_hi:[1,0]
    v_pk_mul_f32 v[170:171], v[170:171], v[16:17] op_sel_hi:[1,0]
    v_pk_mul_f32 v[172:173], v[172:173], v[16:17] op_sel_hi:[1,0]
    v_pk_mul_f32 v[174:175], v[174:175], v[16:17] op_sel_hi:[1,0]
    v_pk_mul_f32 v[176:177], v[176:177], v[16:17] op_sel_hi:[1,0]
    s_add_u32 s29, s28, 926720
    buffer_load_dwordx4 a[68:71], v1, s[12:15], s29 offen
    v_pk_mul_f32 v[178:179], v[178:179], v[16:17] op_sel_hi:[1,0]
    v_pk_mul_f32 v[180:181], v[180:181], v[16:17] op_sel_hi:[1,0]
    v_pk_mul_f32 v[182:183], v[182:183], v[16:17] op_sel_hi:[1,0]
    v_pk_fma_f32 v[40:41], v[56:57], v[18:19], v[40:41] op_sel_hi:[1,0,1]
    v_pk_fma_f32 v[42:43], v[58:59], v[18:19], v[42:43] op_sel_hi:[1,0,1]
    v_pk_fma_f32 v[44:45], v[60:61], v[18:19], v[44:45] op_sel_hi:[1,0,1]
    v_pk_fma_f32 v[46:47], v[62:63], v[18:19], v[46:47] op_sel_hi:[1,0,1]
    v_pk_fma_f32 v[48:49], v[64:65], v[18:19], v[48:49] op_sel_hi:[1,0,1]
    v_pk_fma_f32 v[50:51], v[66:67], v[18:19], v[50:51] op_sel_hi:[1,0,1]
    v_pk_fma_f32 v[52:53], v[68:69], v[18:19], v[52:53] op_sel_hi:[1,0,1]
    v_pk_fma_f32 v[54:55], v[70:71], v[18:19], v[54:55] op_sel_hi:[1,0,1]
    v_pk_fma_f32 v[104:105], v[120:121], v[18:19], v[104:105] op_sel_hi:[1,0,1]
    v_pk_fma_f32 v[106:107], v[122:123], v[18:19], v[106:107] op_sel_hi:[1,0,1]
    v_pk_fma_f32 v[108:109], v[124:125], v[18:19], v[108:109] op_sel_hi:[1,0,1]
    v_pk_fma_f32 v[110:111], v[126:127], v[18:19], v[110:111] op_sel_hi:[1,0,1]
    s_add_u32 s29, s28, 927744
    buffer_load_dwordx4 a[72:75], v1, s[12:15], s29 offen
    v_pk_fma_f32 v[112:113], v[128:129], v[18:19], v[112:113] op_sel_hi:[1,0,1]
    v_pk_fma_f32 v[114:115], v[130:131], v[18:19], v[114:115] op_sel_hi:[1,0,1]
    v_pk_fma_f32 v[116:117], v[132:133], v[18:19], v[116:117] op_sel_hi:[1,0,1]
    v_pk_fma_f32 v[118:119], v[134:135], v[18:19], v[118:119] op_sel_hi:[1,0,1]
    v_pk_fma_f32 v[168:169], v[184:185], v[18:19], v[168:169] op_sel_hi:[1,0,1]
    v_pk_fma_f32 v[170:171], v[186:187], v[18:19], v[170:171] op_sel_hi:[1,0,1]
    v_pk_fma_f32 v[172:173], v[188:189], v[18:19], v[172:173] op_sel_hi:[1,0,1]
    v_pk_fma_f32 v[174:175], v[190:191], v[18:19], v[174:175] op_sel_hi:[1,0,1]
    v_pk_fma_f32 v[176:177], v[192:193], v[18:19], v[176:177] op_sel_hi:[1,0,1]
    v_pk_fma_f32 v[178:179], v[194:195], v[18:19], v[178:179] op_sel_hi:[1,0,1]
    v_pk_fma_f32 v[180:181], v[196:197], v[18:19], v[180:181] op_sel_hi:[1,0,1]
    v_pk_fma_f32 v[182:183], v[198:199], v[18:19], v[182:183] op_sel_hi:[1,0,1]
    s_waitcnt lgkmcnt(12)
    v_pk_fma_f32 v[40:41], v[72:73], v[20:21], v[40:41] op_sel_hi:[1,0,1]
    v_pk_fma_f32 v[42:43], v[74:75], v[20:21], v[42:43] op_sel_hi:[1,0,1]
    s_add_u32 s29, s28, 928768
    buffer_load_dwordx4 a[76:79], v1, s[12:15], s29 offen
    v_pk_fma_f32 v[44:45], v[76:77], v[20:21], v[44:45] op_sel_hi:[1,0,1]
    v_pk_fma_f32 v[46:47], v[78:79], v[20:21], v[46:47] op_sel_hi:[1,0,1]
    v_pk_fma_f32 v[48:49], v[80:81], v[20:21], v[48:49] op_sel_hi:[1,0,1]
    v_pk_fma_f32 v[50:51], v[82:83], v[20:21], v[50:51] op_sel_hi:[1,0,1]
    v_pk_fma_f32 v[52:53], v[84:85], v[20:21], v[52:53] op_sel_hi:[1,0,1]
    v_pk_fma_f32 v[54:55], v[86:87], v[20:21], v[54:55] op_sel_hi:[1,0,1]
    v_pk_fma_f32 v[104:105], v[136:137], v[20:21], v[104:105] op_sel_hi:[1,0,1]
    v_pk_fma_f32 v[106:107], v[138:139], v[20:21], v[106:107] op_sel_hi:[1,0,1]
    v_pk_fma_f32 v[108:109], v[140:141], v[20:21], v[108:109] op_sel_hi:[1,0,1]
    v_pk_fma_f32 v[110:111], v[142:143], v[20:21], v[110:111] op_sel_hi:[1,0,1]
    v_pk_fma_f32 v[112:113], v[144:145], v[20:21], v[112:113] op_sel_hi:[1,0,1]
    v_pk_fma_f32 v[114:115], v[146:147], v[20:21], v[114:115] op_sel_hi:[1,0,1]
    v_pk_fma_f32 v[116:117], v[148:149], v[20:21], v[116:117] op_sel_hi:[1,0,1]
    v_pk_fma_f32 v[118:119], v[150:151], v[20:21], v[118:119] op_sel_hi:[1,0,1]
    v_pk_fma_f32 v[168:169], v[200:201], v[20:21], v[168:169] op_sel_hi:[1,0,1]
    s_add_u32 s29, s28, 929792
    buffer_load_dwordx4 a[80:83], v1, s[12:15], s29 offen
    v_pk_fma_f32 v[170:171], v[202:203], v[20:21], v[170:171] op_sel_hi:[1,0,1]
    v_pk_fma_f32 v[172:173], v[204:205], v[20:21], v[172:173] op_sel_hi:[1,0,1]
    v_pk_fma_f32 v[174:175], v[206:207], v[20:21], v[174:175] op_sel_hi:[1,0,1]
    v_pk_fma_f32 v[176:177], v[208:209], v[20:21], v[176:177] op_sel_hi:[1,0,1]
    v_pk_fma_f32 v[178:179], v[210:211], v[20:21], v[178:179] op_sel_hi:[1,0,1]
    v_pk_fma_f32 v[180:181], v[212:213], v[20:21], v[180:181] op_sel_hi:[1,0,1]
    v_pk_fma_f32 v[182:183], v[214:215], v[20:21], v[182:183] op_sel_hi:[1,0,1]
    s_waitcnt lgkmcnt(0)
    v_pk_fma_f32 v[40:41], v[88:89], v[22:23], v[40:41] op_sel_hi:[1,0,1]
    v_pk_fma_f32 v[42:43], v[90:91], v[22:23], v[42:43] op_sel_hi:[1,0,1]
    v_pk_fma_f32 v[44:45], v[92:93], v[22:23], v[44:45] op_sel_hi:[1,0,1]
    v_pk_fma_f32 v[46:47], v[94:95], v[22:23], v[46:47] op_sel_hi:[1,0,1]
    v_pk_fma_f32 v[48:49], v[96:97], v[22:23], v[48:49] op_sel_hi:[1,0,1]
    v_pk_fma_f32 v[50:51], v[98:99], v[22:23], v[50:51] op_sel_hi:[1,0,1]
    v_pk_fma_f32 v[52:53], v[100:101], v[22:23], v[52:53] op_sel_hi:[1,0,1]
    s_add_u32 s29, s28, 930816
    buffer_load_dwordx4 a[84:87], v1, s[12:15], s29 offen
    v_pk_fma_f32 v[54:55], v[102:103], v[22:23], v[54:55] op_sel_hi:[1,0,1]
    v_pk_fma_f32 v[104:105], v[152:153], v[22:23], v[104:105] op_sel_hi:[1,0,1]
    v_pk_fma_f32 v[106:107], v[154:155], v[22:23], v[106:107] op_sel_hi:[1,0,1]
    v_pk_fma_f32 v[108:109], v[156:157], v[22:23], v[108:109] op_sel_hi:[1,0,1]
    v_pk_fma_f32 v[110:111], v[158:159], v[22:23], v[110:111] op_sel_hi:[1,0,1]
    v_pk_fma_f32 v[112:113], v[160:161], v[22:23], v[112:113] op_sel_hi:[1,0,1]
    v_pk_fma_f32 v[114:115], v[162:163], v[22:23], v[114:115] op_sel_hi:[1,0,1]
    v_pk_fma_f32 v[116:117], v[164:165], v[22:23], v[116:117] op_sel_hi:[1,0,1]
    v_pk_fma_f32 v[118:119], v[166:167], v[22:23], v[118:119] op_sel_hi:[1,0,1]
    v_pk_fma_f32 v[168:169], v[216:217], v[22:23], v[168:169] op_sel_hi:[1,0,1]
    v_pk_fma_f32 v[170:171], v[218:219], v[22:23], v[170:171] op_sel_hi:[1,0,1]
    v_pk_fma_f32 v[172:173], v[220:221], v[22:23], v[172:173] op_sel_hi:[1,0,1]
    v_pk_fma_f32 v[174:175], v[222:223], v[22:23], v[174:175] op_sel_hi:[1,0,1]
    v_pk_fma_f32 v[176:177], v[224:225], v[22:23], v[176:177] op_sel_hi:[1,0,1]
    v_pk_fma_f32 v[178:179], v[226:227], v[22:23], v[178:179] op_sel_hi:[1,0,1]
    s_add_u32 s29, s28, 931840
    buffer_load_dwordx4 a[88:91], v1, s[12:15], s29 offen
    v_pk_fma_f32 v[180:181], v[228:229], v[22:23], v[180:181] op_sel_hi:[1,0,1]
    v_pk_fma_f32 v[182:183], v[230:231], v[22:23], v[182:183] op_sel_hi:[1,0,1]
    v_cvt_pk_bf16_f32 v16, v40, v41
    v_cvt_pk_bf16_f32 v17, v42, v43
    v_cvt_pk_bf16_f32 v18, v44, v45
    v_cvt_pk_bf16_f32 v19, v46, v47
    v_cvt_pk_bf16_f32 v20, v48, v49
    v_cvt_pk_bf16_f32 v21, v50, v51
    v_cvt_pk_bf16_f32 v22, v52, v53
    v_cvt_pk_bf16_f32 v23, v54, v55
    v_cvt_pk_bf16_f32 v24, v104, v105
    v_cvt_pk_bf16_f32 v25, v106, v107
    v_cvt_pk_bf16_f32 v26, v108, v109
    v_cvt_pk_bf16_f32 v27, v110, v111
    v_cvt_pk_bf16_f32 v28, v112, v113
    s_add_u32 s29, s28, 932864
    buffer_load_dwordx4 a[92:95], v1, s[12:15], s29 offen
    v_cvt_pk_bf16_f32 v29, v114, v115
    v_cvt_pk_bf16_f32 v30, v116, v117
    v_cvt_pk_bf16_f32 v31, v118, v119
    v_cvt_pk_bf16_f32 v32, v168, v169
    v_cvt_pk_bf16_f32 v33, v170, v171
    v_cvt_pk_bf16_f32 v34, v172, v173
    v_cvt_pk_bf16_f32 v35, v174, v175
    v_cvt_pk_bf16_f32 v36, v176, v177
    v_cvt_pk_bf16_f32 v37, v178, v179
    v_cvt_pk_bf16_f32 v38, v180, v181
    v_cvt_pk_bf16_f32 v39, v182, v183
    ds_write_b128 v4, v[16:19] offset:24576
    ds_write_b128 v4, v[20:23] offset:25600
    ds_write_b128 v4, v[24:27] offset:26624
    ds_write_b128 v4, v[28:31] offset:27648
    s_add_u32 s29, s28, 933888
    buffer_load_dwordx4 a[96:99], v1, s[12:15], s29 offen
    ds_write_b128 v4, v[32:35] offset:28672
    ds_write_b128 v4, v[36:39] offset:29696
    v_add_u32 v2, 40960, v1
    v_add_u32 v3, 81920, v1
    v_add_u32 v4, 122880, v1
    s_add_u32 s29, s28, 934912
    buffer_load_dwordx4 a[100:103], v1, s[12:15], s29 offen
    s_add_u32 s29, s28, 935936
    buffer_load_dwordx4 a[104:107], v1, s[12:15], s29 offen
    s_add_u32 s29, s28, 936960
    buffer_load_dwordx4 a[108:111], v1, s[12:15], s29 offen
    s_add_u32 s29, s28, 937984
    buffer_load_dwordx4 a[112:115], v1, s[12:15], s29 offen
    s_add_u32 s29, s28, 939008
    buffer_load_dwordx4 a[116:119], v1, s[12:15], s29 offen
    s_add_u32 s29, s28, 940032
    buffer_load_dwordx4 a[120:123], v1, s[12:15], s29 offen
    s_add_u32 s29, s28, 941056
    buffer_load_dwordx4 a[124:127], v1, s[12:15], s29 offen
    s_add_u32 s29, s28, 942080
    buffer_load_dwordx4 a[128:131], v1, s[12:15], s29 offen
    s_add_u32 s29, s28, 943104
    buffer_load_dwordx4 a[132:135], v1, s[12:15], s29 offen
    s_add_u32 s29, s28, 944128
    buffer_load_dwordx4 a[136:139], v1, s[12:15], s29 offen
    s_add_u32 s29, s28, 945152
    buffer_load_dwordx4 a[140:143], v1, s[12:15], s29 offen
    s_add_u32 s29, s28, 946176
    buffer_load_dwordx4 a[144:147], v1, s[12:15], s29 offen
    s_add_u32 s29, s28, 947200
    buffer_load_dwordx4 a[148:151], v1, s[12:15], s29 offen
    s_add_u32 s29, s28, 948224
    buffer_load_dwordx4 a[152:155], v1, s[12:15], s29 offen
    s_add_u32 s29, s28, 949248
    buffer_load_dwordx4 a[156:159], v1, s[12:15], s29 offen
    s_waitcnt lgkmcnt(0)
    s_barrier
    ds_read_b128 v[40:43], v2 offset:24576
    ds_read_b128 v[44:47], v2 offset:25600
    ds_read_b128 v[48:51], v3 offset:24576
    ds_read_b128 v[52:55], v3 offset:25600
    ds_read_b128 v[56:59], v4 offset:24576
    ds_read_b128 v[60:63], v4 offset:25600
    ds_read_b128 v[64:67], v1 offset:24576
    ds_read_b128 v[68:71], v1 offset:25600
    ds_read_b128 v[72:75], v2 offset:26624
    ds_read_b128 v[76:79], v2 offset:27648
    ds_read_b128 v[80:83], v3 offset:26624
    ds_read_b128 v[84:87], v3 offset:27648
    ds_read_b128 v[88:91], v4 offset:26624
    ds_read_b128 v[92:95], v4 offset:27648
    ds_read_b128 v[96:99], v1 offset:26624
    ds_read_b128 v[100:103], v1 offset:27648
    ds_read_b128 v[104:107], v2 offset:28672
    ds_read_b128 v[108:111], v2 offset:29696
    ds_read_b128 v[112:115], v3 offset:28672
    ds_read_b128 v[116:119], v3 offset:29696
    ds_read_b128 v[120:123], v4 offset:28672
    ds_read_b128 v[124:127], v4 offset:29696
    ds_read_b128 v[128:131], v1 offset:28672
    ds_read_b128 v[132:135], v1 offset:29696
    v_mul_u32_u24 v11, 784, v9
    s_mul_i32 s27, s16, 192
    v_add_u32 v11, s27, v11
    v_lshl_add_u32 v11, v10, 3, v11
    s_waitcnt lgkmcnt(15)
    v_mfma_f32_32x32x16_bf16 v[136:151], a[160:163], v[40:43], 0
    s_add_u32 s29, s28, 950272
    buffer_load_dwordx4 a[160:163], v1, s[12:15], s29 offen
    v_mfma_f32_32x32x16_bf16 v[136:151], a[164:167], v[44:47], v[136:151]
    s_add_u32 s29, s28, 951296
    buffer_load_dwordx4 a[164:167], v1, s[12:15], s29 offen
    v_mfma_f32_32x32x16_bf16 v[136:151], a[168:171], v[48:51], v[136:151]
    s_add_u32 s29, s28, 952320
    buffer_load_dwordx4 a[168:171], v1, s[12:15], s29 offen
    v_mfma_f32_32x32x16_bf16 v[136:151], a[172:175], v[52:55], v[136:151]
    s_add_u32 s29, s28, 953344
    buffer_load_dwordx4 a[172:175], v1, s[12:15], s29 offen
    v_mfma_f32_32x32x16_bf16 v[136:151], a[176:179], v[56:59], v[136:151]
    s_add_u32 s29, s28, 954368
    buffer_load_dwordx4 a[176:179], v1, s[12:15], s29 offen
    v_mfma_f32_32x32x16_bf16 v[136:151], a[180:183], v[60:63], v[136:151]
    s_add_u32 s29, s28, 955392
    buffer_load_dwordx4 a[180:183], v1, s[12:15], s29 offen
    v_mfma_f32_32x32x16_bf16 v[136:151], a[184:187], v[64:67], v[136:151]
    s_add_u32 s29, s28, 956416
    buffer_load_dwordx4 a[184:187], v1, s[12:15], s29 offen
    v_mfma_f32_32x32x16_bf16 v[136:151], a[188:191], v[68:71], v[136:151]
    s_add_u32 s29, s28, 957440
    buffer_load_dwordx4 a[188:191], v1, s[12:15], s29 offen
    v_mfma_f32_32x32x16_bf16 v[136:151], a[192:195], v[72:75], v[136:151]
    s_waitcnt lgkmcnt(14)
    v_mfma_f32_32x32x16_bf16 v[136:151], a[196:199], v[76:79], v[136:151]
    s_waitcnt lgkmcnt(13)
    v_mfma_f32_32x32x16_bf16 v[136:151], a[200:203], v[80:83], v[136:151]
    s_waitcnt lgkmcnt(12)
    v_mfma_f32_32x32x16_bf16 v[136:151], a[204:207], v[84:87], v[136:151]
    s_waitcnt lgkmcnt(11)
    v_mfma_f32_32x32x16_bf16 v[136:151], a[208:211], v[88:91], v[136:151]
    s_waitcnt lgkmcnt(10)
    v_mfma_f32_32x32x16_bf16 v[136:151], a[212:215], v[92:95], v[136:151]
    s_waitcnt lgkmcnt(9)
    v_mfma_f32_32x32x16_bf16 v[136:151], a[216:219], v[96:99], v[136:151]
    s_waitcnt lgkmcnt(8)
    v_mfma_f32_32x32x16_bf16 v[136:151], a[220:223], v[100:103], v[136:151]
    s_waitcnt lgkmcnt(7)
    v_mfma_f32_32x32x16_bf16 v[136:151], a[224:227], v[104:107], v[136:151]
    s_waitcnt lgkmcnt(6)
    v_mfma_f32_32x32x16_bf16 v[136:151], a[228:231], v[108:111], v[136:151]
    s_waitcnt lgkmcnt(5)
    v_mfma_f32_32x32x16_bf16 v[136:151], a[232:235], v[112:115], v[136:151]
    s_waitcnt lgkmcnt(4)
    v_mfma_f32_32x32x16_bf16 v[136:151], a[236:239], v[116:119], v[136:151]
    s_waitcnt lgkmcnt(3)
    v_mfma_f32_32x32x16_bf16 v[136:151], a[240:243], v[120:123], v[136:151]
    s_waitcnt lgkmcnt(2)
    v_mfma_f32_32x32x16_bf16 v[136:151], a[244:247], v[124:127], v[136:151]
    s_waitcnt lgkmcnt(1)
    v_mfma_f32_32x32x16_bf16 v[136:151], a[248:251], v[128:131], v[136:151]
    s_waitcnt lgkmcnt(0)
    v_mfma_f32_32x32x16_bf16 v[136:151], a[252:255], v[132:135], v[136:151]
    s_waitcnt vmcnt(47)
    v_mfma_f32_32x32x16_bf16 v[152:167], a[0:3], v[40:43], 0
    s_waitcnt vmcnt(46)
    v_mfma_f32_32x32x16_bf16 v[152:167], a[4:7], v[44:47], v[152:167]
    s_waitcnt vmcnt(45)
    v_mfma_f32_32x32x16_bf16 v[152:167], a[8:11], v[48:51], v[152:167]
    s_waitcnt vmcnt(44)
    v_mfma_f32_32x32x16_bf16 v[152:167], a[12:15], v[52:55], v[152:167]
    s_waitcnt vmcnt(43)
    v_mfma_f32_32x32x16_bf16 v[152:167], a[16:19], v[56:59], v[152:167]
    s_waitcnt vmcnt(42)
    v_mfma_f32_32x32x16_bf16 v[152:167], a[20:23], v[60:63], v[152:167]
    s_waitcnt vmcnt(41)
    v_mfma_f32_32x32x16_bf16 v[152:167], a[24:27], v[64:67], v[152:167]
    s_waitcnt vmcnt(40)
    v_mfma_f32_32x32x16_bf16 v[152:167], a[28:31], v[68:71], v[152:167]
    s_waitcnt vmcnt(39)
    v_mfma_f32_32x32x16_bf16 v[152:167], a[32:35], v[72:75], v[152:167]
    s_waitcnt vmcnt(38)
    v_mfma_f32_32x32x16_bf16 v[152:167], a[36:39], v[76:79], v[152:167]
    s_waitcnt vmcnt(37)
    v_mfma_f32_32x32x16_bf16 v[152:167], a[40:43], v[80:83], v[152:167]
    s_waitcnt vmcnt(36)
    v_mfma_f32_32x32x16_bf16 v[152:167], a[44:47], v[84:87], v[152:167]
    s_waitcnt vmcnt(35)
    v_mfma_f32_32x32x16_bf16 v[152:167], a[48:51], v[88:91], v[152:167]
    s_waitcnt vmcnt(34)
    v_mfma_f32_32x32x16_bf16 v[152:167], a[52:55], v[92:95], v[152:167]
    s_waitcnt vmcnt(33)
    v_mfma_f32_32x32x16_bf16 v[152:167], a[56:59], v[96:99], v[152:167]
    s_waitcnt vmcnt(32)
    v_mfma_f32_32x32x16_bf16 v[152:167], a[60:63], v[100:103], v[152:167]
    s_waitcnt vmcnt(31)
    v_mfma_f32_32x32x16_bf16 v[152:167], a[64:67], v[104:107], v[152:167]
    s_waitcnt vmcnt(30)
    v_mfma_f32_32x32x16_bf16 v[152:167], a[68:71], v[108:111], v[152:167]
    s_waitcnt vmcnt(29)
    v_mfma_f32_32x32x16_bf16 v[152:167], a[72:75], v[112:115], v[152:167]
    s_waitcnt vmcnt(28)
    v_mfma_f32_32x32x16_bf16 v[152:167], a[76:79], v[116:119], v[152:167]
    s_waitcnt vmcnt(27)
    v_mfma_f32_32x32x16_bf16 v[152:167], a[80:83], v[120:123], v[152:167]
    s_waitcnt vmcnt(26)
    v_mfma_f32_32x32x16_bf16 v[152:167], a[84:87], v[124:127], v[152:167]
    s_waitcnt vmcnt(25)
    v_mfma_f32_32x32x16_bf16 v[152:167], a[88:91], v[128:131], v[152:167]
    s_waitcnt vmcnt(24)
    v_mfma_f32_32x32x16_bf16 v[152:167], a[92:95], v[132:135], v[152:167]
    s_waitcnt vmcnt(23)
    v_mfma_f32_32x32x16_bf16 v[168:183], a[96:99], v[40:43], 0
    s_waitcnt vmcnt(22)
    v_mfma_f32_32x32x16_bf16 v[168:183], a[100:103], v[44:47], v[168:183]
    s_waitcnt vmcnt(21)
    v_mfma_f32_32x32x16_bf16 v[168:183], a[104:107], v[48:51], v[168:183]
    s_waitcnt vmcnt(20)
    v_mfma_f32_32x32x16_bf16 v[168:183], a[108:111], v[52:55], v[168:183]
    s_waitcnt vmcnt(19)
    v_mfma_f32_32x32x16_bf16 v[168:183], a[112:115], v[56:59], v[168:183]
    s_waitcnt vmcnt(18)
    v_mfma_f32_32x32x16_bf16 v[168:183], a[116:119], v[60:63], v[168:183]
    s_waitcnt vmcnt(17)
    v_mfma_f32_32x32x16_bf16 v[168:183], a[120:123], v[64:67], v[168:183]
    s_waitcnt vmcnt(16)
    v_mfma_f32_32x32x16_bf16 v[168:183], a[124:127], v[68:71], v[168:183]
    s_waitcnt vmcnt(15)
    v_mfma_f32_32x32x16_bf16 v[168:183], a[128:131], v[72:75], v[168:183]
    s_waitcnt vmcnt(14)
    v_mfma_f32_32x32x16_bf16 v[168:183], a[132:135], v[76:79], v[168:183]
    s_waitcnt vmcnt(13)
    v_mfma_f32_32x32x16_bf16 v[168:183], a[136:139], v[80:83], v[168:183]
    s_waitcnt vmcnt(12)
    v_mfma_f32_32x32x16_bf16 v[168:183], a[140:143], v[84:87], v[168:183]
    s_waitcnt vmcnt(11)
    v_mfma_f32_32x32x16_bf16 v[168:183], a[144:147], v[88:91], v[168:183]
    s_waitcnt vmcnt(10)
    v_mfma_f32_32x32x16_bf16 v[168:183], a[148:151], v[92:95], v[168:183]
    s_waitcnt vmcnt(9)
    v_mfma_f32_32x32x16_bf16 v[168:183], a[152:155], v[96:99], v[168:183]
    s_waitcnt vmcnt(8)
    v_mfma_f32_32x32x16_bf16 v[168:183], a[156:159], v[100:103], v[168:183]
    s_waitcnt vmcnt(7)
    v_mfma_f32_32x32x16_bf16 v[168:183], a[160:163], v[104:107], v[168:183]
    s_waitcnt vmcnt(6)
    v_mfma_f32_32x32x16_bf16 v[168:183], a[164:167], v[108:111], v[168:183]
    s_waitcnt vmcnt(5)
    v_mfma_f32_32x32x16_bf16 v[168:183], a[168:171], v[112:115], v[168:183]
    s_waitcnt vmcnt(4)
    v_mfma_f32_32x32x16_bf16 v[168:183], a[172:175], v[116:119], v[168:183]
    s_waitcnt vmcnt(3)
    v_mfma_f32_32x32x16_bf16 v[168:183], a[176:179], v[120:123], v[168:183]
    s_waitcnt vmcnt(2)
    v_mfma_f32_32x32x16_bf16 v[168:183], a[180:183], v[124:127], v[168:183]
    s_waitcnt vmcnt(1)
    v_mfma_f32_32x32x16_bf16 v[168:183], a[184:187], v[128:131], v[168:183]
    s_waitcnt vmcnt(0)
    v_mfma_f32_32x32x16_bf16 v[168:183], a[188:191], v[132:135], v[168:183]
    v_cvt_pk_bf16_f32 v16, v136, v137
    v_cvt_pk_bf16_f32 v17, v138, v139
    ds_write_b64 v11, v[16:17] offset:0
    v_cvt_pk_bf16_f32 v18, v140, v141
    v_cvt_pk_bf16_f32 v19, v142, v143
    ds_write_b64 v11, v[18:19] offset:16
    v_cvt_pk_bf16_f32 v20, v144, v145
    v_cvt_pk_bf16_f32 v21, v146, v147
    ds_write_b64 v11, v[20:21] offset:32
    v_cvt_pk_bf16_f32 v22, v148, v149
    v_cvt_pk_bf16_f32 v23, v150, v151
    ds_write_b64 v11, v[22:23] offset:48
    v_cvt_pk_bf16_f32 v24, v152, v153
    v_cvt_pk_bf16_f32 v25, v154, v155
    ds_write_b64 v11, v[24:25] offset:64
    v_cvt_pk_bf16_f32 v26, v156, v157
    v_cvt_pk_bf16_f32 v27, v158, v159
    ds_write_b64 v11, v[26:27] offset:80
    v_cvt_pk_bf16_f32 v28, v160, v161
    v_cvt_pk_bf16_f32 v29, v162, v163
    ds_write_b64 v11, v[28:29] offset:96
    v_cvt_pk_bf16_f32 v30, v164, v165
    v_cvt_pk_bf16_f32 v31, v166, v167
    ds_write_b64 v11, v[30:31] offset:112
    v_cvt_pk_bf16_f32 v32, v168, v169
    v_cvt_pk_bf16_f32 v33, v170, v171
    ds_write_b64 v11, v[32:33] offset:128
    v_cvt_pk_bf16_f32 v34, v172, v173
    v_cvt_pk_bf16_f32 v35, v174, v175
    ds_write_b64 v11, v[34:35] offset:144
    v_cvt_pk_bf16_f32 v36, v176, v177
    v_cvt_pk_bf16_f32 v37, v178, v179
    ds_write_b64 v11, v[36:37] offset:160
    v_cvt_pk_bf16_f32 v38, v180, v181
    v_cvt_pk_bf16_f32 v39, v182, v183
    ds_write_b64 v11, v[38:39] offset:176
    s_waitcnt lgkmcnt(0)
    s_barrier
    ds_read_b128 v[40:43], v5 offset:0
    ds_read_b128 v[44:47], v5 offset:128
    ds_read_b128 v[48:51], v5 offset:256
    ds_read_b128 v[52:55], v5 offset:384
    ds_read_b128 v[56:59], v5 offset:512
    ds_read_b128 v[60:63], v5 offset:640
    s_mov_b32 s27, 0xffff0000
    s_waitcnt lgkmcnt(5)
    v_lshlrev_b32 v64, 16, v232
    v_and_b32 v65, s27, v232
    v_lshlrev_b32 v66, 16, v40
    v_and_b32 v67, s27, v40
    v_pk_add_f32 v[64:65], v[64:65], v[66:67]
    v_cvt_pk_bf16_f32 v40, v64, v65
    v_lshlrev_b32 v68, 16, v233
    v_and_b32 v69, s27, v233
    v_lshlrev_b32 v70, 16, v41
    v_and_b32 v71, s27, v41
    v_pk_add_f32 v[68:69], v[68:69], v[70:71]
    v_cvt_pk_bf16_f32 v41, v68, v69
    v_lshlrev_b32 v64, 16, v234
    v_and_b32 v65, s27, v234
    v_lshlrev_b32 v66, 16, v42
    v_and_b32 v67, s27, v42
    v_pk_add_f32 v[64:65], v[64:65], v[66:67]
    v_cvt_pk_bf16_f32 v42, v64, v65
    v_lshlrev_b32 v68, 16, v235
    v_and_b32 v69, s27, v235
    v_lshlrev_b32 v70, 16, v43
    v_and_b32 v71, s27, v43
    v_pk_add_f32 v[68:69], v[68:69], v[70:71]
    v_cvt_pk_bf16_f32 v43, v68, v69
    buffer_store_dwordx4 v[40:43], v15, s[8:11], 0 offen offset:0 sc1
    s_waitcnt lgkmcnt(4)
    v_lshlrev_b32 v64, 16, v236
    v_and_b32 v65, s27, v236
    v_lshlrev_b32 v66, 16, v44
    v_and_b32 v67, s27, v44
    v_pk_add_f32 v[64:65], v[64:65], v[66:67]
    v_cvt_pk_bf16_f32 v44, v64, v65
    v_lshlrev_b32 v68, 16, v237
    v_and_b32 v69, s27, v237
    v_lshlrev_b32 v70, 16, v45
    v_and_b32 v71, s27, v45
    v_pk_add_f32 v[68:69], v[68:69], v[70:71]
    v_cvt_pk_bf16_f32 v45, v68, v69
    v_lshlrev_b32 v64, 16, v238
    v_and_b32 v65, s27, v238
    v_lshlrev_b32 v66, 16, v46
    v_and_b32 v67, s27, v46
    v_pk_add_f32 v[64:65], v[64:65], v[66:67]
    v_cvt_pk_bf16_f32 v46, v64, v65
    v_lshlrev_b32 v68, 16, v239
    v_and_b32 v69, s27, v239
    v_lshlrev_b32 v70, 16, v47
    v_and_b32 v71, s27, v47
    v_pk_add_f32 v[68:69], v[68:69], v[70:71]
    v_cvt_pk_bf16_f32 v47, v68, v69
    buffer_store_dwordx4 v[44:47], v15, s[8:11], 0 offen offset:128 sc1
    s_waitcnt lgkmcnt(3)
    v_lshlrev_b32 v64, 16, v240
    v_and_b32 v65, s27, v240
    v_lshlrev_b32 v66, 16, v48
    v_and_b32 v67, s27, v48
    v_pk_add_f32 v[64:65], v[64:65], v[66:67]
    v_cvt_pk_bf16_f32 v48, v64, v65
    v_lshlrev_b32 v68, 16, v241
    v_and_b32 v69, s27, v241
    v_lshlrev_b32 v70, 16, v49
    v_and_b32 v71, s27, v49
    v_pk_add_f32 v[68:69], v[68:69], v[70:71]
    v_cvt_pk_bf16_f32 v49, v68, v69
    v_lshlrev_b32 v64, 16, v242
    v_and_b32 v65, s27, v242
    v_lshlrev_b32 v66, 16, v50
    v_and_b32 v67, s27, v50
    v_pk_add_f32 v[64:65], v[64:65], v[66:67]
    v_cvt_pk_bf16_f32 v50, v64, v65
    v_lshlrev_b32 v68, 16, v243
    v_and_b32 v69, s27, v243
    v_lshlrev_b32 v70, 16, v51
    v_and_b32 v71, s27, v51
    v_pk_add_f32 v[68:69], v[68:69], v[70:71]
    v_cvt_pk_bf16_f32 v51, v68, v69
    buffer_store_dwordx4 v[48:51], v15, s[8:11], 0 offen offset:256 sc1
    s_waitcnt lgkmcnt(2)
    v_lshlrev_b32 v64, 16, v244
    v_and_b32 v65, s27, v244
    v_lshlrev_b32 v66, 16, v52
    v_and_b32 v67, s27, v52
    v_pk_add_f32 v[64:65], v[64:65], v[66:67]
    v_cvt_pk_bf16_f32 v52, v64, v65
    v_lshlrev_b32 v68, 16, v245
    v_and_b32 v69, s27, v245
    v_lshlrev_b32 v70, 16, v53
    v_and_b32 v71, s27, v53
    v_pk_add_f32 v[68:69], v[68:69], v[70:71]
    v_cvt_pk_bf16_f32 v53, v68, v69
    v_lshlrev_b32 v64, 16, v246
    v_and_b32 v65, s27, v246
    v_lshlrev_b32 v66, 16, v54
    v_and_b32 v67, s27, v54
    v_pk_add_f32 v[64:65], v[64:65], v[66:67]
    v_cvt_pk_bf16_f32 v54, v64, v65
    v_lshlrev_b32 v68, 16, v247
    v_and_b32 v69, s27, v247
    v_lshlrev_b32 v70, 16, v55
    v_and_b32 v71, s27, v55
    v_pk_add_f32 v[68:69], v[68:69], v[70:71]
    v_cvt_pk_bf16_f32 v55, v68, v69
    buffer_store_dwordx4 v[52:55], v15, s[8:11], 0 offen offset:384 sc1
    s_waitcnt lgkmcnt(1)
    v_lshlrev_b32 v64, 16, v248
    v_and_b32 v65, s27, v248
    v_lshlrev_b32 v66, 16, v56
    v_and_b32 v67, s27, v56
    v_pk_add_f32 v[64:65], v[64:65], v[66:67]
    v_cvt_pk_bf16_f32 v56, v64, v65
    v_lshlrev_b32 v68, 16, v249
    v_and_b32 v69, s27, v249
    v_lshlrev_b32 v70, 16, v57
    v_and_b32 v71, s27, v57
    v_pk_add_f32 v[68:69], v[68:69], v[70:71]
    v_cvt_pk_bf16_f32 v57, v68, v69
    v_lshlrev_b32 v64, 16, v250
    v_and_b32 v65, s27, v250
    v_lshlrev_b32 v66, 16, v58
    v_and_b32 v67, s27, v58
    v_pk_add_f32 v[64:65], v[64:65], v[66:67]
    v_cvt_pk_bf16_f32 v58, v64, v65
    v_lshlrev_b32 v68, 16, v251
    v_and_b32 v69, s27, v251
    v_lshlrev_b32 v70, 16, v59
    v_and_b32 v71, s27, v59
    v_pk_add_f32 v[68:69], v[68:69], v[70:71]
    v_cvt_pk_bf16_f32 v59, v68, v69
    buffer_store_dwordx4 v[56:59], v15, s[8:11], 0 offen offset:512 sc1
    s_waitcnt lgkmcnt(0)
    v_lshlrev_b32 v64, 16, v252
    v_and_b32 v65, s27, v252
    v_lshlrev_b32 v66, 16, v60
    v_and_b32 v67, s27, v60
    v_pk_add_f32 v[64:65], v[64:65], v[66:67]
    v_cvt_pk_bf16_f32 v60, v64, v65
    v_lshlrev_b32 v68, 16, v253
    v_and_b32 v69, s27, v253
    v_lshlrev_b32 v70, 16, v61
    v_and_b32 v71, s27, v61
    v_pk_add_f32 v[68:69], v[68:69], v[70:71]
    v_cvt_pk_bf16_f32 v61, v68, v69
    v_lshlrev_b32 v64, 16, v254
    v_and_b32 v65, s27, v254
    v_lshlrev_b32 v66, 16, v62
    v_and_b32 v67, s27, v62
    v_pk_add_f32 v[64:65], v[64:65], v[66:67]
    v_cvt_pk_bf16_f32 v62, v64, v65
    v_lshlrev_b32 v68, 16, v255
    v_and_b32 v69, s27, v255
    v_lshlrev_b32 v70, 16, v63
    v_and_b32 v71, s27, v63
    v_pk_add_f32 v[68:69], v[68:69], v[70:71]
    v_cvt_pk_bf16_f32 v63, v68, v69
    buffer_store_dwordx4 v[60:63], v15, s[8:11], 0 offen offset:640 sc1
K2_END:
    s_endpgm
.section .rodata,"a"
.p2align 6
.amdhsa_kernel temporal_kernel
  .amdhsa_next_free_vgpr 496
  .amdhsa_next_free_sgpr 80
  .amdhsa_accum_offset 256
  .amdhsa_group_segment_fixed_size 0
  .amdhsa_kernarg_size 64
  .amdhsa_user_sgpr_count 2
  .amdhsa_user_sgpr_kernarg_segment_ptr 1
  .amdhsa_system_sgpr_workgroup_id_x 1
  .amdhsa_float_denorm_mode_32 3
.end_amdhsa_kernel
.p2align 6
.amdhsa_kernel spatial_kernel
  .amdhsa_next_free_vgpr 512
  .amdhsa_next_free_sgpr 80
  .amdhsa_accum_offset 256
  .amdhsa_group_segment_fixed_size 0
  .amdhsa_kernarg_size 64
  .amdhsa_user_sgpr_count 2
  .amdhsa_user_sgpr_kernarg_segment_ptr 1
  .amdhsa_system_sgpr_workgroup_id_x 1
  .amdhsa_float_denorm_mode_32 3
.end_amdhsa_kernel
```
